```python
import torch

def _softmax(x, axis=-1):
    return torch.softmax(x, dim=axis)
def _gelu(x):
    return torch.nn.functional.gelu(x, approximate="tanh")
def _silu(x):
    return torch.nn.functional.silu(x)
def _sigmoid(x):
    return torch.sigmoid(x)
def _layernorm(x, axis=-1, eps=1e-5):
    m = x.mean(dim=axis, keepdim=True)
    v = x.var(dim=axis, keepdim=True, unbiased=False)
    return (x - m) / torch.sqrt(v + eps)
def _scatter_add(tgt, idx, src, axis=0):
    return tgt.clone().index_add_(axis, idx, src)
def _segment_sum(src, seg, n):
    out = torch.zeros((n,) + src.shape[1:], dtype=src.dtype)
    return out.index_add_(0, seg, src)
def _pad(x, pw):
    flat = tuple(v for pair in reversed(pw) for v in pair)
    return torch.nn.functional.pad(x, flat)

kernel_name = 'parallel_sum__sliding_block_cached__glu_gated_swiglu__decode'

def setup_inputs():

    _w = (lambda a: (lambda t: t.to(torch.bfloat16) if t.is_floating_point() else t)(torch.as_tensor(a)))
    def _A_setup():
        B, Sq, D = 1, 1, 640
        Hq, Hkv, Sk, Dh = 32, 32, 32768, 192
        assert Hq % Hkv == 0, (Hq, Hkv)
        return {
            "x": _w((lambda *s: torch.randn(*s, dtype=torch.bfloat16) * 0.05)(B, Sq, D)),
            "k_cache": _w((lambda *s: torch.randn(*s, dtype=torch.bfloat16) * 1.6)(B, Hkv, Sk, Dh)),
            "v_cache": _w((lambda *s: torch.randn(*s, dtype=torch.bfloat16) * 0.8)(B, Hkv, Sk, Dh)),
            "wq": _w((lambda *s: torch.randn(*s, dtype=torch.bfloat16) * 1.6)(D, Hq * Dh) * (D ** -0.5)),
            "wo": _w((lambda *s: torch.randn(*s, dtype=torch.bfloat16) * 0.8)(Hq * Dh, D) * ((Hq * Dh) ** -0.5)),
        }
    _A_in = _A_setup()

    def _B_setup():
        B, S, D, F = 1, 1, 640, 1536
        return {
            "x": _w((lambda *s: torch.randn(*s, dtype=torch.bfloat16) * 0.05)(B, S, D)),
            "w1": _w((lambda *s: torch.randn(*s, dtype=torch.bfloat16) * 0.4)(D, F) * (2.0 / D) ** 0.5),
            "w3": _w((lambda *s: torch.randn(*s, dtype=torch.bfloat16) * 0.4)(D, F) * (2.0 / D) ** 0.5),
            "w2": _w((lambda *s: torch.randn(*s, dtype=torch.bfloat16) * 0.4)(F, D) * (2.0 / F) ** 0.5),
        }
    _B_in = _B_setup()

    return {
        "A_x": _A_in["x"],
        "A_k_cache": _A_in["k_cache"],
        "A_v_cache": _A_in["v_cache"],
        "A_wq": _A_in["wq"],
        "A_wo": _A_in["wo"],
        "B_x": _B_in["x"],
        "B_w1": _B_in["w1"],
        "B_w3": _B_in["w3"],
        "B_w2": _B_in["w2"],
    }

def reference(A_x, A_k_cache, A_v_cache, A_wq, A_wo, B_x, B_w1, B_w3, B_w2):
    def _A_ref(x, k_cache, v_cache, wq, wo):
        B, Sq, D = x.shape
        Hq, Dh = 32, 192
        Hkv, Sk = k_cache.shape[1], k_cache.shape[2]
        W = min(4096, max(256, Sk // 4))
        rep = Hq // Hkv
        q = (lambda x, *d: x.permute(*d))((x @ wq).reshape(B, Sq, Hq, Dh), 0, 2, 1, 3)
        k = (lambda x, n, axis: torch.repeat_interleave(x, n, dim=axis))(k_cache[:, :, Sk - W:, :], rep, axis=1)
        v = (lambda x, n, axis: torch.repeat_interleave(x, n, dim=axis))(v_cache[:, :, Sk - W:, :], rep, axis=1)
        scores = torch.einsum("bhqd,bhkd->bhqk", q, k) * (Dh ** -0.5)
        p = _softmax(scores, axis=-1)
        o = torch.einsum("bhqk,bhkd->bhqd", p, v)
        return (lambda x, *d: x.permute(*d))(o, 0, 2, 1, 3).reshape(B, Sq, Hq * Dh) @ wo

    def _B_ref(x, w1, w3, w2):
        gate = torch.einsum("bsd,df->bsf", x, w1)
        up = torch.einsum("bsd,df->bsf", x, w3)
        h = _silu(gate) * up
        out = torch.einsum("bsf,fd->bsd", h, w2)
        return out

    x = A_x
    xn = _layernorm(x, axis=-1)
    return x + _A_ref(xn, A_k_cache, A_v_cache, A_wq, A_wo) + _B_ref(xn, B_w1, B_w3, B_w2)
```

```asm
; @launch grid=(256,1,1) block=(512,1,1) lds=7680
.amdgcn_target "amdgcn-amd-amdhsa--gfx950"
.text
.globl parallel_sum__sliding_block_cached__glu_gated_swiglu__decode_kernel
.p2align 8
.type parallel_sum__sliding_block_cached__glu_gated_swiglu__decode_kernel,@function
parallel_sum__sliding_block_cached__glu_gated_swiglu__decode_kernel:
    s_cmp_ge_u32 s2, 256
    s_cbranch_scc1 L_end
    s_load_dwordx2 s[40:41], s[0:1], 0
    s_load_dwordx2 s[52:53], s[0:1], 24
    s_load_dwordx2 s[76:77], s[0:1], 80
    s_load_dwordx2 s[48:49], s[0:1], 16
    s_load_dwordx2 s[60:61], s[0:1], 48
    s_load_dwordx2 s[64:65], s[0:1], 56
    s_load_dwordx2 s[44:45], s[0:1], 8
    s_load_dwordx2 s[80:81], s[0:1], 88
    s_load_dwordx2 s[56:57], s[0:1], 32
    s_load_dwordx2 s[68:69], s[0:1], 64
    s_load_dwordx2 s[72:73], s[0:1], 72
    s_memrealtime s[36:37]
    v_lshrrev_b32 v2, 6, v0
    v_and_b32 v6, 63, v0
    v_readfirstlane_b32 s5, v2
    v_mov_b32 v5, 0
    v_and_b32 v9, 15, v0
    v_lshlrev_b32 v9, 2, v9
    ds_write_b32 v9, v5 offset:7200
    s_mov_b32 s42, 1280
    s_mov_b32 s43, 0x00020000
    s_mov_b32 s54, 7864320
    s_mov_b32 s55, 0x00020000
    s_mov_b32 s46, 402653184
    s_mov_b32 s47, 0x00020000
    s_mov_b32 s82, 1703936
    s_mov_b32 s83, 0x00020000
    s_mov_b32 s50, 402653184
    s_mov_b32 s51, 0x00020000
    s_mov_b32 s62, 1966080
    s_mov_b32 s63, 0x00020000
    s_mov_b32 s66, 1966080
    s_mov_b32 s67, 0x00020000
    s_mov_b32 s78, 256
    s_mov_b32 s79, 0x00020000
    s_mov_b32 s58, 7864320
    s_mov_b32 s59, 0x00020000
    s_mov_b32 s70, 1966080
    s_mov_b32 s71, 0x00020000
    s_mov_b32 s74, 1280
    s_mov_b32 s75, 0x00020000
    s_and_b32 s3, s2, 7
    s_lshr_b32 s4, s2, 3
    s_and_b32 s6, s4, 3
    s_lshl_b32 s3, s3, 2
    s_add_u32 s3, s3, s6
    s_lshr_b32 s4, s4, 2
    v_lshrrev_b32 v2, 3, v6
    v_and_b32 v3, 7, v6
    v_lshlrev_b32 v4, 4, v3
    v_mul_u32_u24 v1, 384, v2
    v_add_u32 v1, v1, v4
    s_mul_i32 s10, s3, 12582912
    s_mul_i32 s6, s4, 196608
    s_add_u32 s10, s10, s6
    s_and_b32 s7, s5, 3
    s_mul_i32 s6, s7, 49152
    s_add_u32 s10, s10, s6
    s_add_u32 s10, s10, 11010048
    s_lshr_b32 s6, s2, 4
    s_xor_b32 s6, s6, s2
    s_lshl_b32 s7, s7, 2
    s_xor_b32 s6, s6, s7
    s_and_b32 s6, s6, 15
    s_add_u32 s39, s10, 49152
    s_mul_i32 s6, s6, 3072
    s_add_u32 s10, s10, s6
    s_cmp_ge_u32 s5, 4
    s_cbranch_scc1 L_vwave
    s_setprio 2
    s_mul_i32 s6, s4, 80
    s_mul_i32 s7, s5, 20
    s_add_u32 s6, s6, s7
    s_lshl_b32 s9, s6, 1
    s_mul_i32 s11, s6, 12288
    s_mul_i32 s7, s3, 384
    s_add_u32 s11, s11, s7
    s_mul_i32 s17, s6, 3072
    s_mul_i32 s7, s3, 96
    s_add_u32 s17, s17, s7
    v_mul_u32_u24 v5, 20, v6
    v_lshlrev_b32 v9, 1, v2
    v_mul_u32_u24 v10, 12288, v2
    v_add_u32 v10, v10, v4
    v_mul_u32_u24 v11, 3072, v2
    v_add_u32 v11, v11, v4
    v_mov_b32 v12, 1073741824
    v_cmp_gt_u32 vcc, 6, v3
    s_nop 1
    v_cndmask_b32 v11, v12, v11, vcc
    v_cmp_gt_u32 vcc, 32, v6
    s_nop 1
    v_cndmask_b32 v8, v12, v10, vcc
    v_cndmask_b32 v7, v12, v11, vcc
    s_waitcnt lgkmcnt(0)
    buffer_load_dwordx4 v[16:19], v5, s[40:43], 0 offen
    buffer_load_dword v20, v5, s[40:43], 0 offen offset:16
    buffer_load_ushort v60, v9, s[40:43], s9 offen offset:0
    buffer_load_ushort v61, v9, s[40:43], s9 offen offset:16
    buffer_load_ushort v62, v9, s[40:43], s9 offen offset:32
    buffer_load_dwordx4 v[196:199], v10, s[52:55], s11 offen offset:0 nt
    buffer_load_dwordx4 v[200:203], v10, s[52:55], s11 offen offset:128 nt
    buffer_load_dwordx4 v[204:207], v10, s[52:55], s11 offen offset:256 nt
    buffer_load_dwordx4 v[208:211], v11, s[60:63], s17 offen nt
    buffer_load_dwordx4 v[212:215], v11, s[64:67], s17 offen nt
    s_add_u32 s11, s11, 98304
    s_add_u32 s17, s17, 24576
    buffer_load_dwordx4 v[216:219], v10, s[52:55], s11 offen offset:0 nt
    buffer_load_dwordx4 v[220:223], v10, s[52:55], s11 offen offset:128 nt
    buffer_load_dwordx4 v[224:227], v10, s[52:55], s11 offen offset:256 nt
    buffer_load_dwordx4 v[228:231], v11, s[60:63], s17 offen nt
    buffer_load_dwordx4 v[232:235], v11, s[64:67], s17 offen nt
    s_add_u32 s11, s11, 98304
    s_add_u32 s17, s17, 24576
    buffer_load_dwordx4 v[236:239], v8, s[52:55], s11 offen offset:0 nt
    buffer_load_dwordx4 v[240:243], v8, s[52:55], s11 offen offset:128 nt
    buffer_load_dwordx4 v[244:247], v8, s[52:55], s11 offen offset:256 nt
    buffer_load_dwordx4 v[248:251], v7, s[60:63], s17 offen nt
    buffer_load_dwordx4 v[252:255], v7, s[64:67], s17 offen nt
    s_lshl_b32 s13, s3, 15
    s_lshl_b32 s6, s4, 12
    s_add_u32 s12, s13, s6
    s_lshr_b32 s32, s4, 1
    s_and_b32 s33, s4, 1
    s_mul_i32 s34, s33, 327680
    s_lshl_b32 s6, s3, 9
    s_add_u32 s34, s34, s6
    s_lshl_b32 s6, s32, 7
    s_add_u32 s34, s34, s6
    s_add_u32 s34, s34, 1048576
    s_barrier
    s_waitcnt vmcnt(15)
    v_lshlrev_b32 v2, 16, v16
    v_and_b32 v3, 0xffff0000, v16
    v_add_f32 v5, v2, v3
    v_lshlrev_b32 v2, 16, v17
    v_and_b32 v3, 0xffff0000, v17
    v_add_f32 v5, v5, v2
    v_add_f32 v5, v5, v3
    v_lshlrev_b32 v2, 16, v18
    v_and_b32 v3, 0xffff0000, v18
    v_add_f32 v5, v5, v2
    v_add_f32 v5, v5, v3
    v_lshlrev_b32 v2, 16, v19
    v_and_b32 v3, 0xffff0000, v19
    v_add_f32 v5, v5, v2
    v_add_f32 v5, v5, v3
    v_lshlrev_b32 v2, 16, v20
    v_and_b32 v3, 0xffff0000, v20
    v_add_f32 v5, v5, v2
    v_add_f32 v5, v5, v3
    s_nop 1
    v_add_f32 v5, v5, v5 quad_perm:[1,0,3,2] row_mask:0xf bank_mask:0xf
    s_nop 1
    v_add_f32 v5, v5, v5 quad_perm:[2,3,0,1] row_mask:0xf bank_mask:0xf
    s_nop 1
    v_add_f32 v5, v5, v5 row_half_mirror row_mask:0xf bank_mask:0xf
    s_nop 1
    v_add_f32 v5, v5, v5 row_mirror row_mask:0xf bank_mask:0xf
    s_nop 1
    v_mov_b32 v9, v5
    s_nop 1
    v_permlane16_swap_b32 v9, v5
    s_nop 1
    v_add_f32 v5, v9, v5
    s_nop 1
    v_mov_b32 v9, v5
    s_nop 1
    v_permlane32_swap_b32 v9, v5
    s_nop 1
    v_add_f32 v5, v9, v5
    v_mul_f32 v5, 0x3acccccd, v5
    v_mov_b32 v10, 0
    v_lshlrev_b32 v2, 16, v16
    v_and_b32 v3, 0xffff0000, v16
    v_sub_f32 v2, v2, v5
    v_sub_f32 v3, v3, v5
    v_fmac_f32 v10, v2, v2
    v_fmac_f32 v10, v3, v3
    v_lshlrev_b32 v2, 16, v17
    v_and_b32 v3, 0xffff0000, v17
    v_sub_f32 v2, v2, v5
    v_sub_f32 v3, v3, v5
    v_fmac_f32 v10, v2, v2
    v_fmac_f32 v10, v3, v3
    v_lshlrev_b32 v2, 16, v18
    v_and_b32 v3, 0xffff0000, v18
    v_sub_f32 v2, v2, v5
    v_sub_f32 v3, v3, v5
    v_fmac_f32 v10, v2, v2
    v_fmac_f32 v10, v3, v3
    v_lshlrev_b32 v2, 16, v19
    v_and_b32 v3, 0xffff0000, v19
    v_sub_f32 v2, v2, v5
    v_sub_f32 v3, v3, v5
    v_fmac_f32 v10, v2, v2
    v_fmac_f32 v10, v3, v3
    v_lshlrev_b32 v2, 16, v20
    v_and_b32 v3, 0xffff0000, v20
    v_sub_f32 v2, v2, v5
    v_sub_f32 v3, v3, v5
    v_fmac_f32 v10, v2, v2
    v_fmac_f32 v10, v3, v3
    s_nop 1
    v_add_f32 v10, v10, v10 quad_perm:[1,0,3,2] row_mask:0xf bank_mask:0xf
    s_nop 1
    v_add_f32 v10, v10, v10 quad_perm:[2,3,0,1] row_mask:0xf bank_mask:0xf
    s_nop 1
    v_add_f32 v10, v10, v10 row_half_mirror row_mask:0xf bank_mask:0xf
    s_nop 1
    v_add_f32 v10, v10, v10 row_mirror row_mask:0xf bank_mask:0xf
    s_nop 1
    v_mov_b32 v9, v10
    s_nop 1
    v_permlane16_swap_b32 v9, v10
    s_nop 1
    v_add_f32 v10, v9, v10
    s_nop 1
    v_mov_b32 v9, v10
    s_nop 1
    v_permlane32_swap_b32 v9, v10
    s_nop 1
    v_add_f32 v10, v9, v10
    v_mul_f32 v10, 0x3acccccd, v10
    v_cvt_pk_bf16_f32 v5, v5, v5
    v_and_b32 v5, 0xffff0000, v5
    v_cvt_pk_bf16_f32 v10, v10, v10
    v_and_b32 v10, 0xffff0000, v10
    v_add_f32 v10, 0x3727c5ac, v10
    v_cvt_pk_bf16_f32 v10, v10, v10
    v_and_b32 v10, 0xffff0000, v10
    v_sqrt_f32 v10, v10
    s_nop 0
    v_cvt_pk_bf16_f32 v10, v10, v10
    v_and_b32 v10, 0xffff0000, v10
    v_rcp_f32 v11, v10
    s_nop 0
    v_lshlrev_b32 v2, 16, v60
    v_sub_f32 v2, v2, v5
    v_cvt_pk_bf16_f32 v2, v2, v2
    v_and_b32 v2, 0xffff0000, v2
    v_mul_f32 v9, v2, v11
    v_fma_f32 v2, -v9, v10, v2
    v_fmac_f32 v9, v2, v11
    v_cvt_pk_bf16_f32 v60, v9, 0
    v_lshlrev_b32 v2, 16, v61
    v_sub_f32 v2, v2, v5
    v_cvt_pk_bf16_f32 v2, v2, v2
    v_and_b32 v2, 0xffff0000, v2
    v_mul_f32 v9, v2, v11
    v_fma_f32 v2, -v9, v10, v2
    v_fmac_f32 v9, v2, v11
    v_cvt_pk_bf16_f32 v61, v9, 0
    v_lshlrev_b32 v2, 16, v62
    v_sub_f32 v2, v2, v5
    v_cvt_pk_bf16_f32 v2, v2, v2
    v_and_b32 v2, 0xffff0000, v2
    v_mul_f32 v9, v2, v11
    v_fma_f32 v2, -v9, v10, v2
    v_fmac_f32 v9, v2, v11
    v_cvt_pk_bf16_f32 v62, v9, 0
    v_mov_b32 v148, 0
    v_mov_b32 v149, 0
    v_mov_b32 v150, 0
    v_mov_b32 v151, 0
    v_mov_b32 v152, 0
    v_mov_b32 v153, 0
    v_mov_b32 v154, 0
    v_mov_b32 v155, 0
    v_mov_b32 v156, 0
    v_mov_b32 v157, 0
    v_mov_b32 v158, 0
    v_mov_b32 v159, 0
    v_mov_b32 v160, 0
    v_mov_b32 v161, 0
    v_mov_b32 v162, 0
    v_mov_b32 v163, 0
    v_mov_b32 v164, 0
    v_mov_b32 v165, 0
    v_mov_b32 v166, 0
    v_mov_b32 v167, 0
    v_mov_b32 v168, 0
    v_mov_b32 v169, 0
    v_mov_b32 v170, 0
    v_mov_b32 v171, 0
    v_mov_b32 v172, 0
    v_mov_b32 v173, 0
    v_mov_b32 v174, 0
    v_mov_b32 v175, 0
    v_mov_b32 v176, 0
    v_mov_b32 v177, 0
    v_mov_b32 v178, 0
    v_mov_b32 v179, 0
    v_mov_b32 v180, 0
    v_mov_b32 v181, 0
    v_mov_b32 v182, 0
    v_mov_b32 v183, 0
    v_mov_b32 v184, 0
    v_mov_b32 v185, 0
    v_mov_b32 v186, 0
    v_mov_b32 v187, 0
    v_and_b32 v7, 7, v6
    v_lshlrev_b32 v7, 5, v7
    v_lshrrev_b32 v11, 5, v6
    v_lshlrev_b32 v11, 4, v11
    v_add_u32 v7, v7, v11
    v_bfe_u32 v11, v6, 4, 1
    v_lshlrev_b32 v11, 3, v11
    v_add_u32 v7, v7, v11
    s_waitcnt vmcnt(0)
    v_lshlrev_b32 v3, 16, v60
    v_dot2c_f32_bf16 v148, v196, v60
    v_dot2c_f32_bf16 v149, v196, v3
    v_dot2c_f32_bf16 v150, v197, v60
    v_dot2c_f32_bf16 v151, v197, v3
    v_dot2c_f32_bf16 v152, v198, v60
    v_dot2c_f32_bf16 v153, v198, v3
    v_dot2c_f32_bf16 v154, v199, v60
    v_dot2c_f32_bf16 v155, v199, v3
    v_dot2c_f32_bf16 v156, v200, v60
    v_dot2c_f32_bf16 v157, v200, v3
    v_dot2c_f32_bf16 v158, v201, v60
    v_dot2c_f32_bf16 v159, v201, v3
    v_dot2c_f32_bf16 v160, v202, v60
    v_dot2c_f32_bf16 v161, v202, v3
    v_dot2c_f32_bf16 v162, v203, v60
    v_dot2c_f32_bf16 v163, v203, v3
    v_dot2c_f32_bf16 v164, v204, v60
    v_dot2c_f32_bf16 v165, v204, v3
    v_dot2c_f32_bf16 v166, v205, v60
    v_dot2c_f32_bf16 v167, v205, v3
    v_dot2c_f32_bf16 v168, v206, v60
    v_dot2c_f32_bf16 v169, v206, v3
    v_dot2c_f32_bf16 v170, v207, v60
    v_dot2c_f32_bf16 v171, v207, v3
    v_dot2c_f32_bf16 v172, v208, v60
    v_dot2c_f32_bf16 v173, v208, v3
    v_dot2c_f32_bf16 v174, v209, v60
    v_dot2c_f32_bf16 v175, v209, v3
    v_dot2c_f32_bf16 v176, v210, v60
    v_dot2c_f32_bf16 v177, v210, v3
    v_dot2c_f32_bf16 v178, v211, v60
    v_dot2c_f32_bf16 v179, v211, v3
    v_dot2c_f32_bf16 v180, v212, v60
    v_dot2c_f32_bf16 v181, v212, v3
    v_dot2c_f32_bf16 v182, v213, v60
    v_dot2c_f32_bf16 v183, v213, v3
    v_dot2c_f32_bf16 v184, v214, v60
    v_dot2c_f32_bf16 v185, v214, v3
    v_dot2c_f32_bf16 v186, v215, v60
    v_dot2c_f32_bf16 v187, v215, v3
    v_lshlrev_b32 v3, 16, v61
    v_dot2c_f32_bf16 v148, v216, v61
    v_dot2c_f32_bf16 v149, v216, v3
    v_dot2c_f32_bf16 v150, v217, v61
    v_dot2c_f32_bf16 v151, v217, v3
    v_dot2c_f32_bf16 v152, v218, v61
    v_dot2c_f32_bf16 v153, v218, v3
    v_dot2c_f32_bf16 v154, v219, v61
    v_dot2c_f32_bf16 v155, v219, v3
    v_dot2c_f32_bf16 v156, v220, v61
    v_dot2c_f32_bf16 v157, v220, v3
    v_dot2c_f32_bf16 v158, v221, v61
    v_dot2c_f32_bf16 v159, v221, v3
    v_dot2c_f32_bf16 v160, v222, v61
    v_dot2c_f32_bf16 v161, v222, v3
    v_dot2c_f32_bf16 v162, v223, v61
    v_dot2c_f32_bf16 v163, v223, v3
    v_dot2c_f32_bf16 v164, v224, v61
    v_dot2c_f32_bf16 v165, v224, v3
    v_dot2c_f32_bf16 v166, v225, v61
    v_dot2c_f32_bf16 v167, v225, v3
    v_dot2c_f32_bf16 v168, v226, v61
    v_dot2c_f32_bf16 v169, v226, v3
    v_dot2c_f32_bf16 v170, v227, v61
    v_dot2c_f32_bf16 v171, v227, v3
    v_dot2c_f32_bf16 v172, v228, v61
    v_dot2c_f32_bf16 v173, v228, v3
    v_dot2c_f32_bf16 v174, v229, v61
    v_dot2c_f32_bf16 v175, v229, v3
    v_dot2c_f32_bf16 v176, v230, v61
    v_dot2c_f32_bf16 v177, v230, v3
    v_dot2c_f32_bf16 v178, v231, v61
    v_dot2c_f32_bf16 v179, v231, v3
    v_dot2c_f32_bf16 v180, v232, v61
    v_dot2c_f32_bf16 v181, v232, v3
    v_dot2c_f32_bf16 v182, v233, v61
    v_dot2c_f32_bf16 v183, v233, v3
    v_dot2c_f32_bf16 v184, v234, v61
    v_dot2c_f32_bf16 v185, v234, v3
    v_dot2c_f32_bf16 v186, v235, v61
    v_dot2c_f32_bf16 v187, v235, v3
    v_lshlrev_b32 v3, 16, v62
    v_dot2c_f32_bf16 v148, v236, v62
    v_dot2c_f32_bf16 v149, v236, v3
    v_dot2c_f32_bf16 v150, v237, v62
    v_dot2c_f32_bf16 v151, v237, v3
    v_dot2c_f32_bf16 v152, v238, v62
    v_dot2c_f32_bf16 v153, v238, v3
    v_dot2c_f32_bf16 v154, v239, v62
    v_dot2c_f32_bf16 v155, v239, v3
    v_dot2c_f32_bf16 v156, v240, v62
    v_dot2c_f32_bf16 v157, v240, v3
    v_dot2c_f32_bf16 v158, v241, v62
    v_dot2c_f32_bf16 v159, v241, v3
    v_dot2c_f32_bf16 v160, v242, v62
    v_dot2c_f32_bf16 v161, v242, v3
    v_dot2c_f32_bf16 v162, v243, v62
    v_dot2c_f32_bf16 v163, v243, v3
    v_dot2c_f32_bf16 v164, v244, v62
    v_dot2c_f32_bf16 v165, v244, v3
    v_dot2c_f32_bf16 v166, v245, v62
    v_dot2c_f32_bf16 v167, v245, v3
    v_dot2c_f32_bf16 v168, v246, v62
    v_dot2c_f32_bf16 v169, v246, v3
    v_dot2c_f32_bf16 v170, v247, v62
    v_dot2c_f32_bf16 v171, v247, v3
    v_dot2c_f32_bf16 v172, v248, v62
    v_dot2c_f32_bf16 v173, v248, v3
    v_dot2c_f32_bf16 v174, v249, v62
    v_dot2c_f32_bf16 v175, v249, v3
    v_dot2c_f32_bf16 v176, v250, v62
    v_dot2c_f32_bf16 v177, v250, v3
    v_dot2c_f32_bf16 v178, v251, v62
    v_dot2c_f32_bf16 v179, v251, v3
    v_dot2c_f32_bf16 v180, v252, v62
    v_dot2c_f32_bf16 v181, v252, v3
    v_dot2c_f32_bf16 v182, v253, v62
    v_dot2c_f32_bf16 v183, v253, v3
    v_dot2c_f32_bf16 v184, v254, v62
    v_dot2c_f32_bf16 v185, v254, v3
    v_dot2c_f32_bf16 v186, v255, v62
    v_dot2c_f32_bf16 v187, v255, v3
    s_nop 2
    v_permlane32_swap_b32 v148, v152
    v_permlane32_swap_b32 v149, v153
    v_permlane32_swap_b32 v150, v154
    v_permlane32_swap_b32 v151, v155
    v_permlane32_swap_b32 v156, v160
    v_permlane32_swap_b32 v157, v161
    v_permlane32_swap_b32 v158, v162
    v_permlane32_swap_b32 v159, v163
    v_permlane32_swap_b32 v164, v168
    v_permlane32_swap_b32 v165, v169
    v_permlane32_swap_b32 v166, v170
    v_permlane32_swap_b32 v167, v171
    v_permlane32_swap_b32 v172, v176
    v_permlane32_swap_b32 v173, v177
    v_permlane32_swap_b32 v174, v178
    v_permlane32_swap_b32 v175, v179
    v_permlane32_swap_b32 v180, v184
    v_permlane32_swap_b32 v181, v185
    v_permlane32_swap_b32 v182, v186
    v_permlane32_swap_b32 v183, v187
    s_nop 1
    v_add_f32 v148, v148, v152
    v_add_f32 v149, v149, v153
    v_add_f32 v150, v150, v154
    v_add_f32 v151, v151, v155
    v_add_f32 v156, v156, v160
    v_add_f32 v157, v157, v161
    v_add_f32 v158, v158, v162
    v_add_f32 v159, v159, v163
    v_add_f32 v164, v164, v168
    v_add_f32 v165, v165, v169
    v_add_f32 v166, v166, v170
    v_add_f32 v167, v167, v171
    v_add_f32 v172, v172, v176
    v_add_f32 v173, v173, v177
    v_add_f32 v174, v174, v178
    v_add_f32 v175, v175, v179
    v_add_f32 v180, v180, v184
    v_add_f32 v181, v181, v185
    v_add_f32 v182, v182, v186
    v_add_f32 v183, v183, v187
    s_nop 1
    v_permlane16_swap_b32 v148, v150
    v_permlane16_swap_b32 v149, v151
    v_permlane16_swap_b32 v156, v158
    v_permlane16_swap_b32 v157, v159
    v_permlane16_swap_b32 v164, v166
    v_permlane16_swap_b32 v165, v167
    v_permlane16_swap_b32 v172, v174
    v_permlane16_swap_b32 v173, v175
    v_permlane16_swap_b32 v180, v182
    v_permlane16_swap_b32 v181, v183
    s_nop 1
    v_add_f32 v148, v148, v150
    v_add_f32 v149, v149, v151
    v_add_f32 v156, v156, v158
    v_add_f32 v157, v157, v159
    v_add_f32 v164, v164, v166
    v_add_f32 v165, v165, v167
    v_add_f32 v172, v172, v174
    v_add_f32 v173, v173, v175
    v_add_f32 v180, v180, v182
    v_add_f32 v181, v181, v183
    s_nop 1
    v_add_f32 v148, v148, v148 row_ror:8 row_mask:0xf bank_mask:0xf
    v_add_f32 v149, v149, v149 row_ror:8 row_mask:0xf bank_mask:0xf
    v_add_f32 v156, v156, v156 row_ror:8 row_mask:0xf bank_mask:0xf
    v_add_f32 v157, v157, v157 row_ror:8 row_mask:0xf bank_mask:0xf
    v_add_f32 v164, v164, v164 row_ror:8 row_mask:0xf bank_mask:0xf
    v_add_f32 v165, v165, v165 row_ror:8 row_mask:0xf bank_mask:0xf
    v_add_f32 v172, v172, v172 row_ror:8 row_mask:0xf bank_mask:0xf
    v_add_f32 v173, v173, v173 row_ror:8 row_mask:0xf bank_mask:0xf
    v_add_f32 v180, v180, v180 row_ror:8 row_mask:0xf bank_mask:0xf
    v_add_f32 v181, v181, v181 row_ror:8 row_mask:0xf bank_mask:0xf
    s_mul_i32 s6, s5, 768
    v_add_u32 v4, s6, v7
    ds_write_b64 v4, v[148:149] offset:0
    ds_write_b64 v4, v[156:157] offset:256
    ds_write_b64 v4, v[164:165] offset:512
    s_mul_i32 s6, s5, 384
    v_add_u32 v4, s6, v7
    v_and_b32 v3, 7, v6
    v_cmp_gt_u32 vcc, 6, v3
    s_and_saveexec_b64 s[28:29], vcc
    ds_write_b64 v4, v[172:173] offset:3072
    ds_write_b64 v4, v[180:181] offset:3264
    s_mov_b64 exec, s[28:29]
    s_waitcnt lgkmcnt(0)
    v_mov_b32 v2, 0
    v_mov_b32 v3, 1
    s_mov_b64 exec, 1
    ds_add_u32 v2, v3 offset:7200
    s_mov_b64 exec, -1
    s_waitcnt vmcnt(15)
    buffer_load_dwordx4 v[64:67], v1, s[44:47], s10 offen offset:0 nt
    s_waitcnt vmcnt(15)
    buffer_load_dwordx4 v[68:71], v1, s[44:47], s10 offen offset:128 nt
    s_waitcnt vmcnt(15)
    buffer_load_dwordx4 v[72:75], v1, s[44:47], s10 offen offset:256 nt
    s_add_u32 s10, s10, 3072
    s_sub_u32 s19, s10, 49152
    s_cmp_ge_u32 s10, s39
    s_cselect_b32 s10, s19, s10
    s_waitcnt vmcnt(15)
    buffer_load_dwordx4 v[76:79], v1, s[44:47], s10 offen offset:0 nt
    s_waitcnt vmcnt(15)
    buffer_load_dwordx4 v[80:83], v1, s[44:47], s10 offen offset:128 nt
    s_waitcnt vmcnt(15)
    buffer_load_dwordx4 v[84:87], v1, s[44:47], s10 offen offset:256 nt
    s_add_u32 s10, s10, 3072
    s_sub_u32 s19, s10, 49152
    s_cmp_ge_u32 s10, s39
    s_cselect_b32 s10, s19, s10
    s_waitcnt vmcnt(15)
    buffer_load_dwordx4 v[88:91], v1, s[44:47], s10 offen offset:0 nt
    s_waitcnt vmcnt(15)
    buffer_load_dwordx4 v[92:95], v1, s[44:47], s10 offen offset:128 nt
    s_waitcnt vmcnt(15)
    buffer_load_dwordx4 v[96:99], v1, s[44:47], s10 offen offset:256 nt
    s_add_u32 s10, s10, 3072
    s_sub_u32 s19, s10, 49152
    s_cmp_ge_u32 s10, s39
    s_cselect_b32 s10, s19, s10
    s_waitcnt vmcnt(15)
    buffer_load_dwordx4 v[100:103], v1, s[44:47], s10 offen offset:0 nt
    s_waitcnt vmcnt(15)
    buffer_load_dwordx4 v[104:107], v1, s[44:47], s10 offen offset:128 nt
    s_waitcnt vmcnt(15)
    buffer_load_dwordx4 v[108:111], v1, s[44:47], s10 offen offset:256 nt
    s_add_u32 s10, s10, 3072
    s_sub_u32 s19, s10, 49152
    s_cmp_ge_u32 s10, s39
    s_cselect_b32 s10, s19, s10
    s_waitcnt vmcnt(15)
    buffer_load_dwordx4 v[112:115], v1, s[44:47], s10 offen offset:0 nt
    s_waitcnt vmcnt(15)
    buffer_load_dwordx4 v[116:119], v1, s[44:47], s10 offen offset:128 nt
    s_waitcnt vmcnt(15)
    buffer_load_dwordx4 v[120:123], v1, s[44:47], s10 offen offset:256 nt
    s_add_u32 s10, s10, 3072
    s_sub_u32 s19, s10, 49152
    s_cmp_ge_u32 s10, s39
    s_cselect_b32 s10, s19, s10
    s_waitcnt vmcnt(15)
    buffer_load_dwordx4 v[124:127], v1, s[44:47], s10 offen offset:0 nt
    s_waitcnt vmcnt(15)
    buffer_load_dwordx4 v[128:131], v1, s[44:47], s10 offen offset:128 nt
    s_waitcnt vmcnt(15)
    buffer_load_dwordx4 v[132:135], v1, s[44:47], s10 offen offset:256 nt
    s_add_u32 s10, s10, 3072
    s_sub_u32 s19, s10, 49152
    s_cmp_ge_u32 s10, s39
    s_cselect_b32 s10, s19, s10
    s_waitcnt vmcnt(15)
    buffer_load_dwordx4 v[136:139], v1, s[44:47], s10 offen offset:0 nt
    s_waitcnt vmcnt(15)
    buffer_load_dwordx4 v[140:143], v1, s[44:47], s10 offen offset:128 nt
    s_waitcnt vmcnt(15)
    buffer_load_dwordx4 v[144:147], v1, s[44:47], s10 offen offset:256 nt
    s_add_u32 s10, s10, 3072
    s_sub_u32 s19, s10, 49152
    s_cmp_ge_u32 s10, s39
    s_cselect_b32 s10, s19, s10
    s_waitcnt vmcnt(15)
    buffer_load_dwordx4 v[148:151], v1, s[44:47], s10 offen offset:0 nt
    s_waitcnt vmcnt(15)
    buffer_load_dwordx4 v[152:155], v1, s[44:47], s10 offen offset:128 nt
    s_waitcnt vmcnt(15)
    buffer_load_dwordx4 v[156:159], v1, s[44:47], s10 offen offset:256 nt
    s_add_u32 s10, s10, 3072
    s_sub_u32 s19, s10, 49152
    s_cmp_ge_u32 s10, s39
    s_cselect_b32 s10, s19, s10
    s_waitcnt vmcnt(15)
    buffer_load_dwordx4 v[160:163], v1, s[44:47], s10 offen offset:0 nt
    s_waitcnt vmcnt(15)
    buffer_load_dwordx4 v[164:167], v1, s[44:47], s10 offen offset:128 nt
    s_waitcnt vmcnt(15)
    buffer_load_dwordx4 v[168:171], v1, s[44:47], s10 offen offset:256 nt
    s_add_u32 s10, s10, 3072
    s_sub_u32 s19, s10, 49152
    s_cmp_ge_u32 s10, s39
    s_cselect_b32 s10, s19, s10
    s_waitcnt vmcnt(15)
    buffer_load_dwordx4 v[172:175], v1, s[44:47], s10 offen offset:0 nt
    s_waitcnt vmcnt(15)
    buffer_load_dwordx4 v[176:179], v1, s[44:47], s10 offen offset:128 nt
    s_waitcnt vmcnt(15)
    buffer_load_dwordx4 v[180:183], v1, s[44:47], s10 offen offset:256 nt
    s_add_u32 s10, s10, 3072
    s_sub_u32 s19, s10, 49152
    s_cmp_ge_u32 s10, s39
    s_cselect_b32 s10, s19, s10
    s_waitcnt vmcnt(15)
    buffer_load_dwordx4 v[184:187], v1, s[44:47], s10 offen offset:0 nt
    s_waitcnt vmcnt(15)
    buffer_load_dwordx4 v[188:191], v1, s[44:47], s10 offen offset:128 nt
    s_waitcnt vmcnt(15)
    buffer_load_dwordx4 v[192:195], v1, s[44:47], s10 offen offset:256 nt
    s_add_u32 s10, s10, 3072
    s_sub_u32 s19, s10, 49152
    s_cmp_ge_u32 s10, s39
    s_cselect_b32 s10, s19, s10
    s_waitcnt vmcnt(15)
    buffer_load_dwordx4 v[196:199], v1, s[44:47], s10 offen offset:0 nt
    s_waitcnt vmcnt(15)
    buffer_load_dwordx4 v[200:203], v1, s[44:47], s10 offen offset:128 nt
    s_waitcnt vmcnt(15)
    buffer_load_dwordx4 v[204:207], v1, s[44:47], s10 offen offset:256 nt
    s_add_u32 s10, s10, 3072
    s_sub_u32 s19, s10, 49152
    s_cmp_ge_u32 s10, s39
    s_cselect_b32 s10, s19, s10
    s_waitcnt vmcnt(15)
    buffer_load_dwordx4 v[208:211], v1, s[44:47], s10 offen offset:0 nt
    s_waitcnt vmcnt(15)
    buffer_load_dwordx4 v[212:215], v1, s[44:47], s10 offen offset:128 nt
    s_waitcnt vmcnt(15)
    buffer_load_dwordx4 v[216:219], v1, s[44:47], s10 offen offset:256 nt
    s_add_u32 s10, s10, 3072
    s_sub_u32 s19, s10, 49152
    s_cmp_ge_u32 s10, s39
    s_cselect_b32 s10, s19, s10
    s_waitcnt vmcnt(15)
    buffer_load_dwordx4 v[220:223], v1, s[44:47], s10 offen offset:0 nt
    s_waitcnt vmcnt(15)
    buffer_load_dwordx4 v[224:227], v1, s[44:47], s10 offen offset:128 nt
    s_waitcnt vmcnt(15)
    buffer_load_dwordx4 v[228:231], v1, s[44:47], s10 offen offset:256 nt
    s_add_u32 s10, s10, 3072
    s_sub_u32 s19, s10, 49152
    s_cmp_ge_u32 s10, s39
    s_cselect_b32 s10, s19, s10
    s_waitcnt vmcnt(15)
    buffer_load_dwordx4 v[232:235], v1, s[44:47], s10 offen offset:0 nt
    s_waitcnt vmcnt(15)
    buffer_load_dwordx4 v[236:239], v1, s[44:47], s10 offen offset:128 nt
    s_waitcnt vmcnt(15)
    buffer_load_dwordx4 v[240:243], v1, s[44:47], s10 offen offset:256 nt
    s_add_u32 s10, s10, 3072
    s_sub_u32 s19, s10, 49152
    s_cmp_ge_u32 s10, s39
    s_cselect_b32 s10, s19, s10
    s_waitcnt vmcnt(15)
    buffer_load_dwordx4 v[244:247], v1, s[44:47], s10 offen offset:0 nt
    s_waitcnt vmcnt(15)
    buffer_load_dwordx4 v[248:251], v1, s[44:47], s10 offen offset:128 nt
    s_waitcnt vmcnt(15)
    buffer_load_dwordx4 v[252:255], v1, s[44:47], s10 offen offset:256 nt
    s_add_u32 s10, s10, 3072
    s_sub_u32 s19, s10, 49152
    s_cmp_ge_u32 s10, s39
    s_cselect_b32 s10, s19, s10
    s_waitcnt lgkmcnt(0)
    v_mov_b32 v2, 0
    v_mov_b32 v3, 1
    s_mov_b64 exec, 1
    ds_add_u32 v2, v3 offset:7228
    s_mov_b64 exec, -1
    v_mov_b32 v2, 0
    s_mov_b32 s16, 0
L_sp1:
    ds_read_b32 v3, v2 offset:7204
    s_waitcnt lgkmcnt(0)
    v_readfirstlane_b32 s19, v3
    s_add_u32 s16, s16, 1
    s_cmp_ge_u32 s19, 1
    s_cbranch_scc1 L_spd1
    s_cmp_gt_u32 s16, 262144
    s_cbranch_scc1 L_spd1
    s_sleep 1
    s_branch L_sp1
L_spd1:
    v_and_b32 v2, 7, v6
    v_lshlrev_b32 v2, 4, v2
    ds_read_b128 v[16:19], v2 offset:4608
    ds_read_b128 v[20:23], v2 offset:4736
    ds_read_b128 v[24:27], v2 offset:4864
    v_mov_b32 v2, 0
    ds_read_b64 v[14:15], v2 offset:7296
    s_waitcnt lgkmcnt(0)
    v_mov_b32 v28, 0
    v_mov_b32 v2, 0
    v_mov_b32 v3, 0
    v_dot2c_f32_bf16 v28, v64, v16
    v_dot2c_f32_bf16 v2, v68, v20
    v_dot2c_f32_bf16 v3, v72, v24
    v_dot2c_f32_bf16 v28, v65, v17
    v_dot2c_f32_bf16 v2, v69, v21
    v_dot2c_f32_bf16 v3, v73, v25
    v_dot2c_f32_bf16 v28, v66, v18
    v_dot2c_f32_bf16 v2, v70, v22
    v_dot2c_f32_bf16 v3, v74, v26
    v_dot2c_f32_bf16 v28, v67, v19
    v_dot2c_f32_bf16 v2, v71, v23
    v_dot2c_f32_bf16 v3, v75, v27
    s_nop 2
    v_add_f32 v2, v2, v3
    v_add_f32 v28, v28, v2
    v_mov_b32 v29, 0
    v_mov_b32 v2, 0
    v_mov_b32 v3, 0
    v_dot2c_f32_bf16 v29, v76, v16
    v_dot2c_f32_bf16 v2, v80, v20
    v_dot2c_f32_bf16 v3, v84, v24
    v_dot2c_f32_bf16 v29, v77, v17
    v_dot2c_f32_bf16 v2, v81, v21
    v_dot2c_f32_bf16 v3, v85, v25
    v_dot2c_f32_bf16 v29, v78, v18
    v_dot2c_f32_bf16 v2, v82, v22
    v_dot2c_f32_bf16 v3, v86, v26
    v_dot2c_f32_bf16 v29, v79, v19
    v_dot2c_f32_bf16 v2, v83, v23
    v_dot2c_f32_bf16 v3, v87, v27
    s_nop 2
    v_add_f32 v2, v2, v3
    v_add_f32 v29, v29, v2
    v_mov_b32 v30, 0
    v_mov_b32 v2, 0
    v_mov_b32 v3, 0
    v_dot2c_f32_bf16 v30, v88, v16
    v_dot2c_f32_bf16 v2, v92, v20
    v_dot2c_f32_bf16 v3, v96, v24
    v_dot2c_f32_bf16 v30, v89, v17
    v_dot2c_f32_bf16 v2, v93, v21
    v_dot2c_f32_bf16 v3, v97, v25
    v_dot2c_f32_bf16 v30, v90, v18
    v_dot2c_f32_bf16 v2, v94, v22
    v_dot2c_f32_bf16 v3, v98, v26
    v_dot2c_f32_bf16 v30, v91, v19
    v_dot2c_f32_bf16 v2, v95, v23
    v_dot2c_f32_bf16 v3, v99, v27
    s_nop 2
    v_add_f32 v2, v2, v3
    v_add_f32 v30, v30, v2
    v_mov_b32 v31, 0
    v_mov_b32 v2, 0
    v_mov_b32 v3, 0
    v_dot2c_f32_bf16 v31, v100, v16
    v_dot2c_f32_bf16 v2, v104, v20
    v_dot2c_f32_bf16 v3, v108, v24
    v_dot2c_f32_bf16 v31, v101, v17
    v_dot2c_f32_bf16 v2, v105, v21
    v_dot2c_f32_bf16 v3, v109, v25
    v_dot2c_f32_bf16 v31, v102, v18
    v_dot2c_f32_bf16 v2, v106, v22
    v_dot2c_f32_bf16 v3, v110, v26
    v_dot2c_f32_bf16 v31, v103, v19
    v_dot2c_f32_bf16 v2, v107, v23
    v_dot2c_f32_bf16 v3, v111, v27
    s_nop 2
    v_add_f32 v2, v2, v3
    v_add_f32 v31, v31, v2
    v_mov_b32 v32, 0
    v_mov_b32 v2, 0
    v_mov_b32 v3, 0
    v_dot2c_f32_bf16 v32, v112, v16
    v_dot2c_f32_bf16 v2, v116, v20
    v_dot2c_f32_bf16 v3, v120, v24
    v_dot2c_f32_bf16 v32, v113, v17
    v_dot2c_f32_bf16 v2, v117, v21
    v_dot2c_f32_bf16 v3, v121, v25
    v_dot2c_f32_bf16 v32, v114, v18
    v_dot2c_f32_bf16 v2, v118, v22
    v_dot2c_f32_bf16 v3, v122, v26
    v_dot2c_f32_bf16 v32, v115, v19
    v_dot2c_f32_bf16 v2, v119, v23
    v_dot2c_f32_bf16 v3, v123, v27
    s_nop 2
    v_add_f32 v2, v2, v3
    v_add_f32 v32, v32, v2
    v_mov_b32 v33, 0
    v_mov_b32 v2, 0
    v_mov_b32 v3, 0
    v_dot2c_f32_bf16 v33, v124, v16
    v_dot2c_f32_bf16 v2, v128, v20
    v_dot2c_f32_bf16 v3, v132, v24
    v_dot2c_f32_bf16 v33, v125, v17
    v_dot2c_f32_bf16 v2, v129, v21
    v_dot2c_f32_bf16 v3, v133, v25
    v_dot2c_f32_bf16 v33, v126, v18
    v_dot2c_f32_bf16 v2, v130, v22
    v_dot2c_f32_bf16 v3, v134, v26
    v_dot2c_f32_bf16 v33, v127, v19
    v_dot2c_f32_bf16 v2, v131, v23
    v_dot2c_f32_bf16 v3, v135, v27
    s_nop 2
    v_add_f32 v2, v2, v3
    v_add_f32 v33, v33, v2
    v_mov_b32 v34, 0
    v_mov_b32 v2, 0
    v_mov_b32 v3, 0
    v_dot2c_f32_bf16 v34, v136, v16
    v_dot2c_f32_bf16 v2, v140, v20
    v_dot2c_f32_bf16 v3, v144, v24
    v_dot2c_f32_bf16 v34, v137, v17
    v_dot2c_f32_bf16 v2, v141, v21
    v_dot2c_f32_bf16 v3, v145, v25
    v_dot2c_f32_bf16 v34, v138, v18
    v_dot2c_f32_bf16 v2, v142, v22
    v_dot2c_f32_bf16 v3, v146, v26
    v_dot2c_f32_bf16 v34, v139, v19
    v_dot2c_f32_bf16 v2, v143, v23
    v_dot2c_f32_bf16 v3, v147, v27
    s_nop 2
    v_add_f32 v2, v2, v3
    v_add_f32 v34, v34, v2
    v_mov_b32 v35, 0
    v_mov_b32 v2, 0
    v_mov_b32 v3, 0
    v_dot2c_f32_bf16 v35, v148, v16
    v_dot2c_f32_bf16 v2, v152, v20
    v_dot2c_f32_bf16 v3, v156, v24
    v_dot2c_f32_bf16 v35, v149, v17
    v_dot2c_f32_bf16 v2, v153, v21
    v_dot2c_f32_bf16 v3, v157, v25
    v_dot2c_f32_bf16 v35, v150, v18
    v_dot2c_f32_bf16 v2, v154, v22
    v_dot2c_f32_bf16 v3, v158, v26
    v_dot2c_f32_bf16 v35, v151, v19
    v_dot2c_f32_bf16 v2, v155, v23
    v_dot2c_f32_bf16 v3, v159, v27
    s_nop 2
    v_add_f32 v2, v2, v3
    v_add_f32 v35, v35, v2
    v_mov_b32 v36, 0
    v_mov_b32 v2, 0
    v_mov_b32 v3, 0
    v_dot2c_f32_bf16 v36, v160, v16
    v_dot2c_f32_bf16 v2, v164, v20
    v_dot2c_f32_bf16 v3, v168, v24
    v_dot2c_f32_bf16 v36, v161, v17
    v_dot2c_f32_bf16 v2, v165, v21
    v_dot2c_f32_bf16 v3, v169, v25
    v_dot2c_f32_bf16 v36, v162, v18
    v_dot2c_f32_bf16 v2, v166, v22
    v_dot2c_f32_bf16 v3, v170, v26
    v_dot2c_f32_bf16 v36, v163, v19
    v_dot2c_f32_bf16 v2, v167, v23
    v_dot2c_f32_bf16 v3, v171, v27
    s_nop 2
    v_add_f32 v2, v2, v3
    v_add_f32 v36, v36, v2
    v_mov_b32 v37, 0
    v_mov_b32 v2, 0
    v_mov_b32 v3, 0
    v_dot2c_f32_bf16 v37, v172, v16
    v_dot2c_f32_bf16 v2, v176, v20
    v_dot2c_f32_bf16 v3, v180, v24
    v_dot2c_f32_bf16 v37, v173, v17
    v_dot2c_f32_bf16 v2, v177, v21
    v_dot2c_f32_bf16 v3, v181, v25
    v_dot2c_f32_bf16 v37, v174, v18
    v_dot2c_f32_bf16 v2, v178, v22
    v_dot2c_f32_bf16 v3, v182, v26
    v_dot2c_f32_bf16 v37, v175, v19
    v_dot2c_f32_bf16 v2, v179, v23
    v_dot2c_f32_bf16 v3, v183, v27
    s_nop 2
    v_add_f32 v2, v2, v3
    v_add_f32 v37, v37, v2
    s_waitcnt vmcnt(15)
    v_mov_b32 v38, 0
    v_mov_b32 v2, 0
    v_mov_b32 v3, 0
    v_dot2c_f32_bf16 v38, v184, v16
    v_dot2c_f32_bf16 v2, v188, v20
    v_dot2c_f32_bf16 v3, v192, v24
    v_dot2c_f32_bf16 v38, v185, v17
    v_dot2c_f32_bf16 v2, v189, v21
    v_dot2c_f32_bf16 v3, v193, v25
    v_dot2c_f32_bf16 v38, v186, v18
    v_dot2c_f32_bf16 v2, v190, v22
    v_dot2c_f32_bf16 v3, v194, v26
    v_dot2c_f32_bf16 v38, v187, v19
    v_dot2c_f32_bf16 v2, v191, v23
    v_dot2c_f32_bf16 v3, v195, v27
    s_nop 2
    v_add_f32 v2, v2, v3
    v_add_f32 v38, v38, v2
    s_waitcnt vmcnt(12)
    v_mov_b32 v39, 0
    v_mov_b32 v2, 0
    v_mov_b32 v3, 0
    v_dot2c_f32_bf16 v39, v196, v16
    v_dot2c_f32_bf16 v2, v200, v20
    v_dot2c_f32_bf16 v3, v204, v24
    v_dot2c_f32_bf16 v39, v197, v17
    v_dot2c_f32_bf16 v2, v201, v21
    v_dot2c_f32_bf16 v3, v205, v25
    v_dot2c_f32_bf16 v39, v198, v18
    v_dot2c_f32_bf16 v2, v202, v22
    v_dot2c_f32_bf16 v3, v206, v26
    v_dot2c_f32_bf16 v39, v199, v19
    v_dot2c_f32_bf16 v2, v203, v23
    v_dot2c_f32_bf16 v3, v207, v27
    s_nop 2
    v_add_f32 v2, v2, v3
    v_add_f32 v39, v39, v2
    s_waitcnt vmcnt(9)
    v_mov_b32 v40, 0
    v_mov_b32 v2, 0
    v_mov_b32 v3, 0
    v_dot2c_f32_bf16 v40, v208, v16
    v_dot2c_f32_bf16 v2, v212, v20
    v_dot2c_f32_bf16 v3, v216, v24
    v_dot2c_f32_bf16 v40, v209, v17
    v_dot2c_f32_bf16 v2, v213, v21
    v_dot2c_f32_bf16 v3, v217, v25
    v_dot2c_f32_bf16 v40, v210, v18
    v_dot2c_f32_bf16 v2, v214, v22
    v_dot2c_f32_bf16 v3, v218, v26
    v_dot2c_f32_bf16 v40, v211, v19
    v_dot2c_f32_bf16 v2, v215, v23
    v_dot2c_f32_bf16 v3, v219, v27
    s_nop 2
    v_add_f32 v2, v2, v3
    v_add_f32 v40, v40, v2
    s_waitcnt vmcnt(6)
    v_mov_b32 v41, 0
    v_mov_b32 v2, 0
    v_mov_b32 v3, 0
    v_dot2c_f32_bf16 v41, v220, v16
    v_dot2c_f32_bf16 v2, v224, v20
    v_dot2c_f32_bf16 v3, v228, v24
    v_dot2c_f32_bf16 v41, v221, v17
    v_dot2c_f32_bf16 v2, v225, v21
    v_dot2c_f32_bf16 v3, v229, v25
    v_dot2c_f32_bf16 v41, v222, v18
    v_dot2c_f32_bf16 v2, v226, v22
    v_dot2c_f32_bf16 v3, v230, v26
    v_dot2c_f32_bf16 v41, v223, v19
    v_dot2c_f32_bf16 v2, v227, v23
    v_dot2c_f32_bf16 v3, v231, v27
    s_nop 2
    v_add_f32 v2, v2, v3
    v_add_f32 v41, v41, v2
    s_waitcnt vmcnt(3)
    v_mov_b32 v42, 0
    v_mov_b32 v2, 0
    v_mov_b32 v3, 0
    v_dot2c_f32_bf16 v42, v232, v16
    v_dot2c_f32_bf16 v2, v236, v20
    v_dot2c_f32_bf16 v3, v240, v24
    v_dot2c_f32_bf16 v42, v233, v17
    v_dot2c_f32_bf16 v2, v237, v21
    v_dot2c_f32_bf16 v3, v241, v25
    v_dot2c_f32_bf16 v42, v234, v18
    v_dot2c_f32_bf16 v2, v238, v22
    v_dot2c_f32_bf16 v3, v242, v26
    v_dot2c_f32_bf16 v42, v235, v19
    v_dot2c_f32_bf16 v2, v239, v23
    v_dot2c_f32_bf16 v3, v243, v27
    s_nop 2
    v_add_f32 v2, v2, v3
    v_add_f32 v42, v42, v2
    s_waitcnt vmcnt(0)
    v_mov_b32 v43, 0
    v_mov_b32 v2, 0
    v_mov_b32 v3, 0
    v_dot2c_f32_bf16 v43, v244, v16
    v_dot2c_f32_bf16 v2, v248, v20
    v_dot2c_f32_bf16 v3, v252, v24
    v_dot2c_f32_bf16 v43, v245, v17
    v_dot2c_f32_bf16 v2, v249, v21
    v_dot2c_f32_bf16 v3, v253, v25
    v_dot2c_f32_bf16 v43, v246, v18
    v_dot2c_f32_bf16 v2, v250, v22
    v_dot2c_f32_bf16 v3, v254, v26
    v_dot2c_f32_bf16 v43, v247, v19
    v_dot2c_f32_bf16 v2, v251, v23
    v_dot2c_f32_bf16 v3, v255, v27
    s_nop 2
    v_add_f32 v2, v2, v3
    v_add_f32 v43, v43, v2
    v_add_f32 v28, v28, v28 quad_perm:[1,0,3,2] row_mask:0xf bank_mask:0xf
    v_add_f32 v29, v29, v29 quad_perm:[1,0,3,2] row_mask:0xf bank_mask:0xf
    v_add_f32 v30, v30, v30 quad_perm:[1,0,3,2] row_mask:0xf bank_mask:0xf
    v_add_f32 v31, v31, v31 quad_perm:[1,0,3,2] row_mask:0xf bank_mask:0xf
    v_add_f32 v32, v32, v32 quad_perm:[1,0,3,2] row_mask:0xf bank_mask:0xf
    v_add_f32 v33, v33, v33 quad_perm:[1,0,3,2] row_mask:0xf bank_mask:0xf
    v_add_f32 v34, v34, v34 quad_perm:[1,0,3,2] row_mask:0xf bank_mask:0xf
    v_add_f32 v35, v35, v35 quad_perm:[1,0,3,2] row_mask:0xf bank_mask:0xf
    v_add_f32 v36, v36, v36 quad_perm:[1,0,3,2] row_mask:0xf bank_mask:0xf
    v_add_f32 v37, v37, v37 quad_perm:[1,0,3,2] row_mask:0xf bank_mask:0xf
    v_add_f32 v38, v38, v38 quad_perm:[1,0,3,2] row_mask:0xf bank_mask:0xf
    v_add_f32 v39, v39, v39 quad_perm:[1,0,3,2] row_mask:0xf bank_mask:0xf
    v_add_f32 v40, v40, v40 quad_perm:[1,0,3,2] row_mask:0xf bank_mask:0xf
    v_add_f32 v41, v41, v41 quad_perm:[1,0,3,2] row_mask:0xf bank_mask:0xf
    v_add_f32 v42, v42, v42 quad_perm:[1,0,3,2] row_mask:0xf bank_mask:0xf
    v_add_f32 v43, v43, v43 quad_perm:[1,0,3,2] row_mask:0xf bank_mask:0xf
    v_add_f32 v28, v28, v28 quad_perm:[2,3,0,1] row_mask:0xf bank_mask:0xf
    v_add_f32 v29, v29, v29 quad_perm:[2,3,0,1] row_mask:0xf bank_mask:0xf
    v_add_f32 v30, v30, v30 quad_perm:[2,3,0,1] row_mask:0xf bank_mask:0xf
    v_add_f32 v31, v31, v31 quad_perm:[2,3,0,1] row_mask:0xf bank_mask:0xf
    v_add_f32 v32, v32, v32 quad_perm:[2,3,0,1] row_mask:0xf bank_mask:0xf
    v_add_f32 v33, v33, v33 quad_perm:[2,3,0,1] row_mask:0xf bank_mask:0xf
    v_add_f32 v34, v34, v34 quad_perm:[2,3,0,1] row_mask:0xf bank_mask:0xf
    v_add_f32 v35, v35, v35 quad_perm:[2,3,0,1] row_mask:0xf bank_mask:0xf
    v_add_f32 v36, v36, v36 quad_perm:[2,3,0,1] row_mask:0xf bank_mask:0xf
    v_add_f32 v37, v37, v37 quad_perm:[2,3,0,1] row_mask:0xf bank_mask:0xf
    v_add_f32 v38, v38, v38 quad_perm:[2,3,0,1] row_mask:0xf bank_mask:0xf
    v_add_f32 v39, v39, v39 quad_perm:[2,3,0,1] row_mask:0xf bank_mask:0xf
    v_add_f32 v40, v40, v40 quad_perm:[2,3,0,1] row_mask:0xf bank_mask:0xf
    v_add_f32 v41, v41, v41 quad_perm:[2,3,0,1] row_mask:0xf bank_mask:0xf
    v_add_f32 v42, v42, v42 quad_perm:[2,3,0,1] row_mask:0xf bank_mask:0xf
    v_add_f32 v43, v43, v43 quad_perm:[2,3,0,1] row_mask:0xf bank_mask:0xf
    v_add_f32 v28, v28, v28 row_half_mirror row_mask:0xf bank_mask:0xf
    v_add_f32 v29, v29, v29 row_half_mirror row_mask:0xf bank_mask:0xf
    v_add_f32 v30, v30, v30 row_half_mirror row_mask:0xf bank_mask:0xf
    v_add_f32 v31, v31, v31 row_half_mirror row_mask:0xf bank_mask:0xf
    v_add_f32 v32, v32, v32 row_half_mirror row_mask:0xf bank_mask:0xf
    v_add_f32 v33, v33, v33 row_half_mirror row_mask:0xf bank_mask:0xf
    v_add_f32 v34, v34, v34 row_half_mirror row_mask:0xf bank_mask:0xf
    v_add_f32 v35, v35, v35 row_half_mirror row_mask:0xf bank_mask:0xf
    v_add_f32 v36, v36, v36 row_half_mirror row_mask:0xf bank_mask:0xf
    v_add_f32 v37, v37, v37 row_half_mirror row_mask:0xf bank_mask:0xf
    v_add_f32 v38, v38, v38 row_half_mirror row_mask:0xf bank_mask:0xf
    v_add_f32 v39, v39, v39 row_half_mirror row_mask:0xf bank_mask:0xf
    v_add_f32 v40, v40, v40 row_half_mirror row_mask:0xf bank_mask:0xf
    v_add_f32 v41, v41, v41 row_half_mirror row_mask:0xf bank_mask:0xf
    v_add_f32 v42, v42, v42 row_half_mirror row_mask:0xf bank_mask:0xf
    v_add_f32 v43, v43, v43 row_half_mirror row_mask:0xf bank_mask:0xf
    v_cvt_pk_bf16_f32 v28, v28, v28
    v_and_b32 v28, 0xffff0000, v28
    v_mul_f32 v28, 0x3d93cd3a, v28
    v_cvt_pk_bf16_f32 v28, v28, v28
    v_and_b32 v28, 0xffff0000, v28
    v_cvt_pk_bf16_f32 v29, v29, v29
    v_and_b32 v29, 0xffff0000, v29
    v_mul_f32 v29, 0x3d93cd3a, v29
    v_cvt_pk_bf16_f32 v29, v29, v29
    v_and_b32 v29, 0xffff0000, v29
    v_cvt_pk_bf16_f32 v30, v30, v30
    v_and_b32 v30, 0xffff0000, v30
    v_mul_f32 v30, 0x3d93cd3a, v30
    v_cvt_pk_bf16_f32 v30, v30, v30
    v_and_b32 v30, 0xffff0000, v30
    v_cvt_pk_bf16_f32 v31, v31, v31
    v_and_b32 v31, 0xffff0000, v31
    v_mul_f32 v31, 0x3d93cd3a, v31
    v_cvt_pk_bf16_f32 v31, v31, v31
    v_and_b32 v31, 0xffff0000, v31
    v_cvt_pk_bf16_f32 v32, v32, v32
    v_and_b32 v32, 0xffff0000, v32
    v_mul_f32 v32, 0x3d93cd3a, v32
    v_cvt_pk_bf16_f32 v32, v32, v32
    v_and_b32 v32, 0xffff0000, v32
    v_cvt_pk_bf16_f32 v33, v33, v33
    v_and_b32 v33, 0xffff0000, v33
    v_mul_f32 v33, 0x3d93cd3a, v33
    v_cvt_pk_bf16_f32 v33, v33, v33
    v_and_b32 v33, 0xffff0000, v33
    v_cvt_pk_bf16_f32 v34, v34, v34
    v_and_b32 v34, 0xffff0000, v34
    v_mul_f32 v34, 0x3d93cd3a, v34
    v_cvt_pk_bf16_f32 v34, v34, v34
    v_and_b32 v34, 0xffff0000, v34
    v_cvt_pk_bf16_f32 v35, v35, v35
    v_and_b32 v35, 0xffff0000, v35
    v_mul_f32 v35, 0x3d93cd3a, v35
    v_cvt_pk_bf16_f32 v35, v35, v35
    v_and_b32 v35, 0xffff0000, v35
    v_cvt_pk_bf16_f32 v36, v36, v36
    v_and_b32 v36, 0xffff0000, v36
    v_mul_f32 v36, 0x3d93cd3a, v36
    v_cvt_pk_bf16_f32 v36, v36, v36
    v_and_b32 v36, 0xffff0000, v36
    v_cvt_pk_bf16_f32 v37, v37, v37
    v_and_b32 v37, 0xffff0000, v37
    v_mul_f32 v37, 0x3d93cd3a, v37
    v_cvt_pk_bf16_f32 v37, v37, v37
    v_and_b32 v37, 0xffff0000, v37
    v_cvt_pk_bf16_f32 v38, v38, v38
    v_and_b32 v38, 0xffff0000, v38
    v_mul_f32 v38, 0x3d93cd3a, v38
    v_cvt_pk_bf16_f32 v38, v38, v38
    v_and_b32 v38, 0xffff0000, v38
    v_cvt_pk_bf16_f32 v39, v39, v39
    v_and_b32 v39, 0xffff0000, v39
    v_mul_f32 v39, 0x3d93cd3a, v39
    v_cvt_pk_bf16_f32 v39, v39, v39
    v_and_b32 v39, 0xffff0000, v39
    v_cvt_pk_bf16_f32 v40, v40, v40
    v_and_b32 v40, 0xffff0000, v40
    v_mul_f32 v40, 0x3d93cd3a, v40
    v_cvt_pk_bf16_f32 v40, v40, v40
    v_and_b32 v40, 0xffff0000, v40
    v_cvt_pk_bf16_f32 v41, v41, v41
    v_and_b32 v41, 0xffff0000, v41
    v_mul_f32 v41, 0x3d93cd3a, v41
    v_cvt_pk_bf16_f32 v41, v41, v41
    v_and_b32 v41, 0xffff0000, v41
    v_cvt_pk_bf16_f32 v42, v42, v42
    v_and_b32 v42, 0xffff0000, v42
    v_mul_f32 v42, 0x3d93cd3a, v42
    v_cvt_pk_bf16_f32 v42, v42, v42
    v_and_b32 v42, 0xffff0000, v42
    v_cvt_pk_bf16_f32 v43, v43, v43
    v_and_b32 v43, 0xffff0000, v43
    v_mul_f32 v43, 0x3d93cd3a, v43
    v_cvt_pk_bf16_f32 v43, v43, v43
    v_and_b32 v43, 0xffff0000, v43
    v_max3_f32 v8, v28, v29, v30
    v_max3_f32 v8, v8, v31, v32
    v_max3_f32 v8, v8, v33, v34
    v_max3_f32 v8, v8, v35, v36
    v_max3_f32 v8, v8, v37, v38
    v_max3_f32 v8, v8, v39, v40
    v_max3_f32 v8, v8, v41, v42
    v_max_f32 v8, v8, v43
    s_nop 1
    v_max_f32 v8, v8, v8 row_ror:8 row_mask:0xf bank_mask:0xf
    s_nop 1
    v_mov_b32 v3, v8
    s_nop 1
    v_permlane16_swap_b32 v3, v8
    s_nop 1
    v_max_f32 v8, v3, v8
    s_nop 1
    v_mov_b32 v3, v8
    s_nop 1
    v_permlane32_swap_b32 v3, v8
    s_nop 1
    v_max_f32 v8, v3, v8
    v_mov_b32 v4, 0
    v_sub_f32 v28, v28, v8
    v_mul_f32 v28, 0x3fb8aa3b, v28
    v_exp_f32 v28, v28
    s_nop 0
    v_add_f32 v4, v4, v28
    v_cvt_pk_bf16_f32 v28, v28, 0
    v_sub_f32 v29, v29, v8
    v_mul_f32 v29, 0x3fb8aa3b, v29
    v_exp_f32 v29, v29
    s_nop 0
    v_add_f32 v4, v4, v29
    v_cvt_pk_bf16_f32 v29, v29, 0
    v_sub_f32 v30, v30, v8
    v_mul_f32 v30, 0x3fb8aa3b, v30
    v_exp_f32 v30, v30
    s_nop 0
    v_add_f32 v4, v4, v30
    v_cvt_pk_bf16_f32 v30, v30, 0
    v_sub_f32 v31, v31, v8
    v_mul_f32 v31, 0x3fb8aa3b, v31
    v_exp_f32 v31, v31
    s_nop 0
    v_add_f32 v4, v4, v31
    v_cvt_pk_bf16_f32 v31, v31, 0
    v_sub_f32 v32, v32, v8
    v_mul_f32 v32, 0x3fb8aa3b, v32
    v_exp_f32 v32, v32
    s_nop 0
    v_add_f32 v4, v4, v32
    v_cvt_pk_bf16_f32 v32, v32, 0
    v_sub_f32 v33, v33, v8
    v_mul_f32 v33, 0x3fb8aa3b, v33
    v_exp_f32 v33, v33
    s_nop 0
    v_add_f32 v4, v4, v33
    v_cvt_pk_bf16_f32 v33, v33, 0
    v_sub_f32 v34, v34, v8
    v_mul_f32 v34, 0x3fb8aa3b, v34
    v_exp_f32 v34, v34
    s_nop 0
    v_add_f32 v4, v4, v34
    v_cvt_pk_bf16_f32 v34, v34, 0
    v_sub_f32 v35, v35, v8
    v_mul_f32 v35, 0x3fb8aa3b, v35
    v_exp_f32 v35, v35
    s_nop 0
    v_add_f32 v4, v4, v35
    v_cvt_pk_bf16_f32 v35, v35, 0
    v_sub_f32 v36, v36, v8
    v_mul_f32 v36, 0x3fb8aa3b, v36
    v_exp_f32 v36, v36
    s_nop 0
    v_add_f32 v4, v4, v36
    v_cvt_pk_bf16_f32 v36, v36, 0
    v_sub_f32 v37, v37, v8
    v_mul_f32 v37, 0x3fb8aa3b, v37
    v_exp_f32 v37, v37
    s_nop 0
    v_add_f32 v4, v4, v37
    v_cvt_pk_bf16_f32 v37, v37, 0
    v_sub_f32 v38, v38, v8
    v_mul_f32 v38, 0x3fb8aa3b, v38
    v_exp_f32 v38, v38
    s_nop 0
    v_add_f32 v4, v4, v38
    v_cvt_pk_bf16_f32 v38, v38, 0
    v_sub_f32 v39, v39, v8
    v_mul_f32 v39, 0x3fb8aa3b, v39
    v_exp_f32 v39, v39
    s_nop 0
    v_add_f32 v4, v4, v39
    v_cvt_pk_bf16_f32 v39, v39, 0
    v_sub_f32 v40, v40, v8
    v_mul_f32 v40, 0x3fb8aa3b, v40
    v_exp_f32 v40, v40
    s_nop 0
    v_add_f32 v4, v4, v40
    v_cvt_pk_bf16_f32 v40, v40, 0
    v_sub_f32 v41, v41, v8
    v_mul_f32 v41, 0x3fb8aa3b, v41
    v_exp_f32 v41, v41
    s_nop 0
    v_add_f32 v4, v4, v41
    v_cvt_pk_bf16_f32 v41, v41, 0
    v_sub_f32 v42, v42, v8
    v_mul_f32 v42, 0x3fb8aa3b, v42
    v_exp_f32 v42, v42
    s_nop 0
    v_add_f32 v4, v4, v42
    v_cvt_pk_bf16_f32 v42, v42, 0
    v_sub_f32 v43, v43, v8
    v_mul_f32 v43, 0x3fb8aa3b, v43
    v_exp_f32 v43, v43
    s_nop 0
    v_add_f32 v4, v4, v43
    v_cvt_pk_bf16_f32 v43, v43, 0
    v_lshrrev_b32 v9, 3, v6
    v_lshlrev_b32 v9, 6, v9
    s_lshl_b32 s7, s5, 9
    v_add_u32 v9, s7, v9
    v_and_b32 v3, 7, v6
    v_cmp_eq_u32 vcc, 0, v3
    s_and_saveexec_b64 s[28:29], vcc
    ds_write_b128 v9, v[28:31] offset:5120
    ds_write_b128 v9, v[32:35] offset:5136
    ds_write_b128 v9, v[36:39] offset:5152
    ds_write_b128 v9, v[40:43] offset:5168
    s_mov_b64 exec, s[28:29]
    s_lshl_b32 s6, s5, 2
    v_mov_b32 v5, s6
    s_waitcnt lgkmcnt(0)
    v_mov_b32 v3, 1
    ds_write_b32 v5, v3 offset:7232
    s_nop 1
    v_add_f32 v4, v4, v4 row_ror:8 row_mask:0xf bank_mask:0xf
    s_nop 1
    v_mov_b32 v3, v4
    s_nop 1
    v_permlane16_swap_b32 v3, v4
    s_nop 1
    v_add_f32 v4, v3, v4
    s_nop 1
    v_mov_b32 v3, v4
    s_nop 1
    v_permlane32_swap_b32 v3, v4
    s_nop 1
    v_add_f32 v4, v3, v4
    ds_write_b32 v5, v8 offset:7168
    ds_write_b32 v5, v4 offset:7184
    s_waitcnt lgkmcnt(0)
    v_mov_b32 v2, 0
    v_mov_b32 v3, 1
    s_mov_b64 exec, 1
    ds_add_u32 v2, v3 offset:7208
    s_mov_b64 exec, -1
    s_cmp_eq_u32 s5, 2
    s_cbranch_scc1 L_ffn
    s_cmp_lg_u32 s5, 1
    s_cbranch_scc1 L_kwo
    v_mov_b32 v2, 0
    s_mov_b32 s16, 0
L_sp2:
    ds_read_b32 v3, v2 offset:7208
    s_waitcnt lgkmcnt(0)
    v_readfirstlane_b32 s19, v3
    s_add_u32 s16, s16, 1
    s_cmp_ge_u32 s19, 4
    s_cbranch_scc1 L_spd2
    s_cmp_gt_u32 s16, 262144
    s_cbranch_scc1 L_spd2
    s_sleep 1
    s_branch L_sp2
L_spd2:
    ds_read_b128 v[44:47], v2 offset:7168
    ds_read_b128 v[48:51], v2 offset:7184
    s_waitcnt lgkmcnt(0)
    v_max3_f32 v52, v44, v45, v46
    v_max_f32 v52, v52, v47
    v_mov_b32 v53, 0
    v_sub_f32 v44, v44, v52
    v_mul_f32 v44, 0x3fb8aa3b, v44
    v_exp_f32 v44, v44
    s_nop 0
    v_fmac_f32 v53, v44, v48
    v_sub_f32 v45, v45, v52
    v_mul_f32 v45, 0x3fb8aa3b, v45
    v_exp_f32 v45, v45
    s_nop 0
    v_fmac_f32 v53, v45, v49
    v_sub_f32 v46, v46, v52
    v_mul_f32 v46, 0x3fb8aa3b, v46
    v_exp_f32 v46, v46
    s_nop 0
    v_fmac_f32 v53, v46, v50
    v_sub_f32 v47, v47, v52
    v_mul_f32 v47, 0x3fb8aa3b, v47
    v_exp_f32 v47, v47
    s_nop 0
    v_fmac_f32 v53, v47, v51
    v_mov_b32 v54, v14
    v_mov_b32 v55, v15
    v_mov_b32 v2, 0
    ds_read_b32 v3, v2 offset:7304
    s_waitcnt lgkmcnt(0)
    v_readfirstlane_b32 s35, v3
    s_mov_b64 exec, 1
    s_cmp_eq_u32 s35, 0
    s_cbranch_scc1 L_gs1
    buffer_store_dwordx4 v[52:55], v2, s[80:83], s12 offen offset:3840 sc1
    s_branch L_gsd1
L_gs1:
    buffer_store_dwordx4 v[52:55], v2, s[80:83], s12 offen offset:3840
L_gsd1:
    s_mov_b64 exec, -1
    s_branch L_kwo
L_ffn:
    v_lshrrev_b32 v4, 3, v6
    v_lshlrev_b32 v4, 12, v4
    v_and_b32 v5, 7, v6
    v_lshlrev_b32 v9, 4, v5
    v_add_u32 v4, v4, v9
    v_mov_b32 v3, 1073741824
    v_cmp_gt_u32 s[30:31], 6, v5
    s_nop 1
    v_cndmask_b32 v4, v3, v4, s[30:31]
    s_mul_i32 s6, s32, 96
    s_add_u32 s6, s6, s13
    s_mov_b32 s16, 0
L_pff:
    buffer_load_dwordx4 v[44:47], v4, s[80:83], s6 offen offset:3072 sc1
    buffer_load_dwordx4 v[48:51], v4, s[80:83], s6 offen offset:3456 sc1
    s_waitcnt vmcnt(0)
    v_xor_b32 v3, v46, v14
    v_xor_b32 v9, v47, v15
    v_or_b32 v3, v3, v9
    v_xor_b32 v50, v50, v14
    v_xor_b32 v51, v51, v15
    v_or3_b32 v3, v3, v50, v51
    v_cmp_ne_u32 vcc, 0, v3
    s_add_u32 s16, s16, 1
    s_and_b64 vcc, vcc, s[30:31]
    s_cmp_gt_u32 s16, 16384
    s_cbranch_scc1 L_pff_done
    s_cbranch_vccnz L_pff
L_pff_done:
    s_nop 1
    v_add_f32 v44, v44, v44 row_ror:8 row_mask:0xf bank_mask:0xf
    s_nop 1
    v_mov_b32 v3, v44
    s_nop 1
    v_permlane16_swap_b32 v3, v44
    s_nop 1
    v_add_f32 v44, v3, v44
    s_nop 1
    v_mov_b32 v3, v44
    s_nop 1
    v_permlane32_swap_b32 v3, v44
    s_nop 1
    v_add_f32 v44, v3, v44
    s_nop 1
    v_add_f32 v45, v45, v45 row_ror:8 row_mask:0xf bank_mask:0xf
    s_nop 1
    v_mov_b32 v3, v45
    s_nop 1
    v_permlane16_swap_b32 v3, v45
    s_nop 1
    v_add_f32 v45, v3, v45
    s_nop 1
    v_mov_b32 v3, v45
    s_nop 1
    v_permlane32_swap_b32 v3, v45
    s_nop 1
    v_add_f32 v45, v3, v45
    s_nop 1
    v_add_f32 v48, v48, v48 row_ror:8 row_mask:0xf bank_mask:0xf
    s_nop 1
    v_mov_b32 v3, v48
    s_nop 1
    v_permlane16_swap_b32 v3, v48
    s_nop 1
    v_add_f32 v48, v3, v48
    s_nop 1
    v_mov_b32 v3, v48
    s_nop 1
    v_permlane32_swap_b32 v3, v48
    s_nop 1
    v_add_f32 v48, v3, v48
    s_nop 1
    v_add_f32 v49, v49, v49 row_ror:8 row_mask:0xf bank_mask:0xf
    s_nop 1
    v_mov_b32 v3, v49
    s_nop 1
    v_permlane16_swap_b32 v3, v49
    s_nop 1
    v_add_f32 v49, v3, v49
    s_nop 1
    v_mov_b32 v3, v49
    s_nop 1
    v_permlane32_swap_b32 v3, v49
    s_nop 1
    v_add_f32 v49, v3, v49
    v_cvt_pk_bf16_f32 v44, v44, v44
    v_and_b32 v44, 0xffff0000, v44
    v_cvt_pk_bf16_f32 v48, v48, v48
    v_and_b32 v48, 0xffff0000, v48
    v_mul_f32 v3, 0xbfb8aa3b, v44
    v_exp_f32 v3, v3
    s_nop 0
    v_add_f32 v3, 1.0, v3
    v_rcp_f32 v3, v3
    s_nop 0
    v_mul_f32 v3, v44, v3
    v_cvt_pk_bf16_f32 v3, v3, v3
    v_and_b32 v3, 0xffff0000, v3
    v_mul_f32 v3, v3, v48
    v_cvt_pk_bf16_f32 v52, v3, 0
    v_cvt_pk_bf16_f32 v45, v45, v45
    v_and_b32 v45, 0xffff0000, v45
    v_cvt_pk_bf16_f32 v49, v49, v49
    v_and_b32 v49, 0xffff0000, v49
    v_mul_f32 v3, 0xbfb8aa3b, v45
    v_exp_f32 v3, v3
    s_nop 0
    v_add_f32 v3, 1.0, v3
    v_rcp_f32 v3, v3
    s_nop 0
    v_mul_f32 v3, v45, v3
    v_cvt_pk_bf16_f32 v3, v3, v3
    v_and_b32 v3, 0xffff0000, v3
    v_mul_f32 v3, v3, v49
    v_cvt_pk_bf16_f32 v53, v3, 0
    v_and_b32 v4, 3, v6
    v_lshlrev_b32 v4, 6, v4
    v_and_b32 v9, 4, v6
    v_add_u32 v4, v4, v9
    s_mov_b64 exec, 0xff
    ds_write_b32 v4, v52 offset:7448
    ds_write_b32 v4, v53 offset:7480
    s_mov_b64 exec, -1
    s_waitcnt lgkmcnt(0)
    v_mov_b32 v2, 0
    v_mov_b32 v3, 1
    s_mov_b64 exec, 1
    ds_add_u32 v2, v3 offset:7212
    s_mov_b64 exec, -1
L_kwo:
    v_mov_b32 v2, 0
    s_mov_b32 s16, 0
L_sp3:
    ds_read_b32 v3, v2 offset:7224
    s_waitcnt lgkmcnt(0)
    v_readfirstlane_b32 s19, v3
    s_add_u32 s16, s16, 1
    s_cmp_ge_u32 s19, 4
    s_cbranch_scc1 L_spd3
    s_cmp_gt_u32 s16, 262144
    s_cbranch_scc1 L_spd3
    s_sleep 1
    s_branch L_sp3
L_spd3:
    v_lshrrev_b32 v2, 3, v6
    v_and_b32 v3, 7, v6
    v_lshlrev_b32 v3, 4, v3
    v_mul_u32_u24 v9, 1280, v2
    v_add_u32 v9, v9, v3
    v_mov_b32 v4, 1073741824
    v_cmp_gt_u32 vcc, 32, v6
    s_nop 1
    v_cndmask_b32 v10, v4, v9, vcc
    s_mul_i32 s6, s33, 640
    s_lshl_b32 s7, s5, 7
    s_add_u32 s6, s6, s7
    s_lshl_b32 s7, s3, 2
    s_add_u32 s7, s7, s32
    s_mul_i32 s14, s7, 61440
    s_add_u32 s14, s14, s6
    s_mul_i32 s15, s7, 15360
    s_add_u32 s15, s15, s6
    buffer_load_dwordx4 v[88:91], v9, s[68:71], s15 offen nt
    s_add_u32 s15, s15, 10240
    buffer_load_dwordx4 v[92:95], v10, s[68:71], s15 offen nt
    buffer_load_dwordx4 v[64:67], v9, s[56:59], s14 offen nt
    s_add_u32 s14, s14, 10240
    buffer_load_dwordx4 v[68:71], v9, s[56:59], s14 offen nt
    s_add_u32 s14, s14, 10240
    buffer_load_dwordx4 v[72:75], v9, s[56:59], s14 offen nt
    s_add_u32 s14, s14, 10240
    buffer_load_dwordx4 v[76:79], v9, s[56:59], s14 offen nt
    s_add_u32 s14, s14, 10240
    buffer_load_dwordx4 v[80:83], v9, s[56:59], s14 offen nt
    s_add_u32 s14, s14, 10240
    buffer_load_dwordx4 v[84:87], v9, s[56:59], s14 offen nt
    s_setprio 3
    s_cmp_lg_u32 s5, 0
    s_cbranch_scc1 L_stagec
    v_and_b32 v4, 7, v6
    v_lshlrev_b32 v4, 12, v4
    s_mov_b32 s16, 0
L_pml:
    buffer_load_dwordx4 v[44:47], v4, s[80:83], s13 offen offset:3840 sc1
    s_waitcnt vmcnt(0)
    v_xor_b32 v3, v46, v14
    v_xor_b32 v9, v47, v15
    v_or_b32 v3, v3, v9
    v_cmp_ne_u32 vcc, 0, v3
    s_add_u32 s16, s16, 1
    s_cmp_gt_u32 s16, 16384
    s_cbranch_scc1 L_pml_done
    s_cbranch_vccnz L_pml
L_pml_done:
    v_mov_b32 v3, v44
    s_nop 1
    v_max_f32 v3, v3, v3 quad_perm:[1,0,3,2] row_mask:0xf bank_mask:0xf
    s_nop 1
    v_max_f32 v3, v3, v3 quad_perm:[2,3,0,1] row_mask:0xf bank_mask:0xf
    s_nop 1
    v_max_f32 v3, v3, v3 row_half_mirror row_mask:0xf bank_mask:0xf
    v_sub_f32 v3, v44, v3
    v_mul_f32 v3, 0x3fb8aa3b, v3
    v_exp_f32 v3, v3
    s_nop 0
    v_mul_f32 v4, v3, v45
    s_nop 1
    v_add_f32 v4, v4, v4 quad_perm:[1,0,3,2] row_mask:0xf bank_mask:0xf
    s_nop 1
    v_add_f32 v4, v4, v4 quad_perm:[2,3,0,1] row_mask:0xf bank_mask:0xf
    s_nop 1
    v_add_f32 v4, v4, v4 row_half_mirror row_mask:0xf bank_mask:0xf
    v_rcp_f32 v4, v4
    s_nop 0
    v_mul_f32 v5, v3, v4
    v_and_b32 v4, 1, v6
    v_lshlrev_b32 v4, 4, v4
    v_and_b32 v9, 6, v6
    v_lshlrev_b32 v9, 1, v9
    v_add_u32 v4, v4, v9
    ds_write_b32 v4, v5 offset:7264
    s_waitcnt lgkmcnt(0)
    v_mov_b32 v2, 0
    v_mov_b32 v3, 1
    s_mov_b64 exec, 1
    ds_add_u32 v2, v3 offset:7216
    s_mov_b64 exec, -1
    s_branch L_stagec
L_vwave:
    s_setprio 1
    s_lshl_b32 s13, s3, 15
    s_lshl_b32 s6, s4, 12
    s_add_u32 s12, s13, s6
    s_lshr_b32 s32, s4, 1
    s_and_b32 s33, s4, 1
    s_mul_i32 s34, s33, 327680
    s_lshl_b32 s6, s3, 9
    s_add_u32 s34, s34, s6
    s_lshl_b32 s6, s32, 7
    s_add_u32 s34, s34, s6
    s_add_u32 s34, s34, 1048576
    s_waitcnt lgkmcnt(0)
    s_cmp_lg_u32 s5, 7
    s_cbranch_scc1 L_notag
    s_setprio 3
    v_mov_b32 v5, 0
    s_cmp_lg_u32 s2, 0
    s_cbranch_scc1 L_tagrd
    s_or_b32 s37, s37, 0x80000000
    v_mov_b32 v16, s36
    v_mov_b32 v17, s37
    v_mov_b32 v18, 0
    v_mov_b32 v19, 0
    s_mov_b64 exec, 1
    buffer_atomic_cmpswap_x2 v[16:19], v5, s[76:79], 0 offen sc1
    s_mov_b64 exec, -1
L_tagrd:
    buffer_load_dwordx2 v[14:15], v5, s[76:79], 0 offen sc1
    s_barrier
    s_mov_b32 s16, 0
L_tagl:
    s_waitcnt vmcnt(0)
    v_cmp_eq_u32 vcc, 0, v15
    s_add_u32 s16, s16, 1
    s_cmp_gt_u32 s16, 16384
    s_cbranch_scc1 L_tagok
    s_cbranch_vccz L_tagok
    buffer_load_dwordx2 v[14:15], v5, s[76:79], 0 offen sc1
    s_branch L_tagl
L_tagok:
    ds_write_b64 v5, v[14:15] offset:7296
    s_waitcnt lgkmcnt(0)
    v_mov_b32 v2, 0
    v_mov_b32 v3, 1
    s_mov_b64 exec, 1
    ds_add_u32 v2, v3 offset:7200
    s_mov_b64 exec, -1
    s_setprio 1
    s_branch L_vgo
L_notag:
    s_barrier
L_vgo:
    buffer_load_dwordx4 v[64:67], v1, s[48:51], s10 offen offset:0 nt
    buffer_load_dwordx4 v[68:71], v1, s[48:51], s10 offen offset:128 nt
    buffer_load_dwordx4 v[72:75], v1, s[48:51], s10 offen offset:256 nt
    s_add_u32 s10, s10, 3072
    s_sub_u32 s19, s10, 49152
    s_cmp_ge_u32 s10, s39
    s_cselect_b32 s10, s19, s10
    buffer_load_dwordx4 v[76:79], v1, s[48:51], s10 offen offset:0 nt
    buffer_load_dwordx4 v[80:83], v1, s[48:51], s10 offen offset:128 nt
    buffer_load_dwordx4 v[84:87], v1, s[48:51], s10 offen offset:256 nt
    s_add_u32 s10, s10, 3072
    s_sub_u32 s19, s10, 49152
    s_cmp_ge_u32 s10, s39
    s_cselect_b32 s10, s19, s10
    s_cmp_eq_u32 s5, 4
    s_cbranch_scc1 L_vrest
    s_cmp_eq_u32 s5, 7
    s_cbranch_scc1 L_vrest
    s_setprio 3
    v_mov_b32 v2, 0
    s_mov_b32 s16, 0
L_sp4:
    ds_read_b32 v3, v2 offset:7200
    s_waitcnt lgkmcnt(0)
    v_readfirstlane_b32 s19, v3
    s_add_u32 s16, s16, 1
    s_cmp_ge_u32 s19, 5
    s_cbranch_scc1 L_spd4
    s_cmp_gt_u32 s16, 262144
    s_cbranch_scc1 L_spd4
    s_branch L_sp4
L_spd4:
    v_mov_b32 v2, 0
    ds_read_b64 v[14:15], v2 offset:7296
    s_waitcnt lgkmcnt(0)
    s_cmp_eq_u32 s5, 5
    s_cbranch_scc1 L_w5
    v_lshlrev_b32 v4, 3, v6
    v_lshlrev_b32 v5, 4, v6
    ds_read_b64 v[20:21], v4 offset:3072
    ds_read_b64 v[22:23], v4 offset:3456
    ds_read_b64 v[24:25], v4 offset:3840
    ds_read_b64 v[26:27], v4 offset:4224
    v_mov_b32 v18, v14
    v_mov_b32 v19, v15
    s_waitcnt lgkmcnt(0)
    v_add_f32 v20, v20, v22
    v_add_f32 v24, v24, v26
    v_add_f32 v21, v21, v23
    v_add_f32 v25, v25, v27
    v_add_f32 v16, v20, v24
    v_add_f32 v17, v21, v25
    v_cmp_gt_u32 vcc, 48, v6
    s_and_saveexec_b64 s[28:29], vcc
    buffer_store_dwordx4 v[16:19], v5, s[80:83], s12 offen offset:3072
    s_mov_b64 exec, s[28:29]
    s_branch L_vsvc_done
L_w5:
    s_getreg_b32 s8, hwreg(HW_REG_XCC_ID)
    s_and_b32 s8, s8, 15
    v_lshlrev_b32 v4, 3, v6
    v_lshlrev_b32 v5, 4, v6
    ds_read_b64 v[24:25], v4 offset:0
    ds_read_b64 v[26:27], v4 offset:768
    ds_read_b64 v[28:29], v4 offset:1536
    ds_read_b64 v[30:31], v4 offset:2304
    ds_read_b64 v[32:33], v4 offset:512
    ds_read_b64 v[34:35], v4 offset:1280
    ds_read_b64 v[36:37], v4 offset:2048
    ds_read_b64 v[38:39], v4 offset:2816
    v_mov_b32 v18, v14
    v_mov_b32 v19, v15
    v_mov_b32 v22, v14
    v_mov_b32 v23, v15
    s_waitcnt lgkmcnt(4)
    v_add_f32 v24, v24, v26
    v_add_f32 v28, v28, v30
    v_add_f32 v25, v25, v27
    v_add_f32 v29, v29, v31
    v_add_f32 v16, v24, v28
    v_add_f32 v17, v25, v29
    buffer_store_dwordx4 v[16:19], v5, s[80:83], s12 offen offset:0
    s_waitcnt lgkmcnt(0)
    v_add_f32 v32, v32, v34
    v_add_f32 v36, v36, v38
    v_add_f32 v33, v33, v35
    v_add_f32 v37, v37, v39
    v_add_f32 v20, v32, v36
    v_add_f32 v21, v33, v37
    s_mov_b32 exec_hi, 0
    buffer_store_dwordx4 v[20:23], v5, s[80:83], s12 offen offset:1024
    s_mov_b64 exec, -1
    v_mov_b32 v44, s8
    v_mov_b32 v45, 0
    v_mov_b32 v46, v14
    v_mov_b32 v47, v15
    v_mov_b32 v2, 0
    s_mov_b64 exec, 1
    buffer_store_dwordx4 v[44:47], v2, s[80:83], s12 offen offset:3968
    s_mov_b64 exec, -1
    s_mov_b32 s35, 0
    v_and_b32 v10, 7, v6
    v_lshlrev_b32 v10, 12, v10
    s_mov_b32 s16, 0
L_gp:
    buffer_load_dwordx4 v[40:43], v10, s[80:83], s13 offen offset:3968 sc1
    s_waitcnt vmcnt(0)
    v_xor_b32 v3, v42, v14
    v_xor_b32 v9, v43, v15
    v_or_b32 v3, v3, v9
    v_cmp_ne_u32 vcc, 0, v3
    s_add_u32 s16, s16, 1
    s_cbranch_vccz L_gp_all
    s_cmp_gt_u32 s16, 16384
    s_cbranch_scc1 L_gp_done
    s_cmp_lg_u32 s16, 4
    s_cbranch_scc1 L_gp
    s_cmp_lg_u32 s35, 0
    s_cbranch_scc1 L_gp
L_goslow:
    s_mov_b32 s35, 1
    v_lshlrev_b32 v4, 3, v6
    v_lshlrev_b32 v5, 4, v6
    ds_read_b64 v[24:25], v4 offset:0
    ds_read_b64 v[26:27], v4 offset:768
    ds_read_b64 v[28:29], v4 offset:1536
    ds_read_b64 v[30:31], v4 offset:2304
    ds_read_b64 v[32:33], v4 offset:512
    ds_read_b64 v[34:35], v4 offset:1280
    ds_read_b64 v[36:37], v4 offset:2048
    ds_read_b64 v[38:39], v4 offset:2816
    v_mov_b32 v18, v14
    v_mov_b32 v19, v15
    v_mov_b32 v22, v14
    v_mov_b32 v23, v15
    s_waitcnt lgkmcnt(4)
    v_add_f32 v24, v24, v26
    v_add_f32 v28, v28, v30
    v_add_f32 v25, v25, v27
    v_add_f32 v29, v29, v31
    v_add_f32 v16, v24, v28
    v_add_f32 v17, v25, v29
    buffer_store_dwordx4 v[16:19], v5, s[80:83], s12 offen offset:0 sc1
    s_waitcnt lgkmcnt(0)
    v_add_f32 v32, v32, v34
    v_add_f32 v36, v36, v38
    v_add_f32 v33, v33, v35
    v_add_f32 v37, v37, v39
    v_add_f32 v20, v32, v36
    v_add_f32 v21, v33, v37
    s_mov_b32 exec_hi, 0
    buffer_store_dwordx4 v[20:23], v5, s[80:83], s12 offen offset:1024 sc1
    s_mov_b64 exec, -1
    v_mov_b32 v44, s8
    v_mov_b32 v45, 0
    v_mov_b32 v46, v14
    v_mov_b32 v47, v15
    v_mov_b32 v2, 0
    s_mov_b64 exec, 1
    buffer_store_dwordx4 v[44:47], v2, s[80:83], s12 offen offset:3968 sc1
    s_mov_b64 exec, -1
    v_lshlrev_b32 v4, 3, v6
    v_lshlrev_b32 v5, 4, v6
    ds_read_b64 v[52:53], v4 offset:3072
    ds_read_b64 v[54:55], v4 offset:3456
    ds_read_b64 v[56:57], v4 offset:3840
    ds_read_b64 v[58:59], v4 offset:4224
    v_mov_b32 v50, v14
    v_mov_b32 v51, v15
    s_waitcnt lgkmcnt(0)
    v_add_f32 v52, v52, v54
    v_add_f32 v56, v56, v58
    v_add_f32 v53, v53, v55
    v_add_f32 v57, v57, v59
    v_add_f32 v48, v52, v56
    v_add_f32 v49, v53, v57
    v_cmp_gt_u32 vcc, 48, v6
    s_and_saveexec_b64 s[28:29], vcc
    buffer_store_dwordx4 v[48:51], v5, s[80:83], s12 offen offset:3072 sc1
    s_mov_b64 exec, s[28:29]
    s_branch L_gp
L_gp_all:
    s_cmp_lg_u32 s35, 0
    s_cbranch_scc1 L_gp_done
    v_cmp_ne_u32 vcc, s8, v40
    s_cbranch_vccnz L_goslow
L_gp_done:
    v_mov_b32 v2, 0
    v_mov_b32 v3, s35
    ds_write_b32 v2, v3 offset:7304
    v_lshlrev_b32 v5, 4, v6
    v_and_b32 v4, 31, v6
    v_lshlrev_b32 v4, 4, v4
    v_lshrrev_b32 v9, 5, v6
    v_lshlrev_b32 v9, 12, v9
    v_add_u32 v4, v4, v9
    s_add_u32 s20, s13, 0
    s_add_u32 s21, s13, 4096
    s_add_u32 s22, s13, 8192
    s_add_u32 s23, s13, 12288
    s_add_u32 s24, s13, 16384
    s_add_u32 s25, s13, 20480
    s_add_u32 s26, s13, 24576
    s_add_u32 s27, s13, 28672
    s_mov_b32 s16, 0
L_gq:
    buffer_load_dwordx4 v[16:19], v5, s[80:83], s20 offen offset:0 sc1
    buffer_load_dwordx4 v[20:23], v5, s[80:83], s21 offen offset:0 sc1
    buffer_load_dwordx4 v[24:27], v5, s[80:83], s22 offen offset:0 sc1
    buffer_load_dwordx4 v[28:31], v5, s[80:83], s23 offen offset:0 sc1
    buffer_load_dwordx4 v[32:35], v5, s[80:83], s24 offen offset:0 sc1
    buffer_load_dwordx4 v[36:39], v5, s[80:83], s25 offen offset:0 sc1
    buffer_load_dwordx4 v[40:43], v5, s[80:83], s26 offen offset:0 sc1
    buffer_load_dwordx4 v[44:47], v5, s[80:83], s27 offen offset:0 sc1
    buffer_load_dwordx4 v[48:51], v4, s[80:83], s20 offen offset:1024 sc1
    buffer_load_dwordx4 v[52:55], v4, s[80:83], s22 offen offset:1024 sc1
    buffer_load_dwordx4 v[56:59], v4, s[80:83], s24 offen offset:1024 sc1
    buffer_load_dwordx4 v[60:63], v4, s[80:83], s26 offen offset:1024 sc1
    s_waitcnt vmcnt(0)
    v_xor_b32 v3, v18, v14
    v_xor_b32 v9, v19, v15
    v_or_b32 v3, v3, v9
    v_xor_b32 v22, v22, v14
    v_xor_b32 v23, v23, v15
    v_or3_b32 v3, v3, v22, v23
    v_xor_b32 v26, v26, v14
    v_xor_b32 v27, v27, v15
    v_or3_b32 v3, v3, v26, v27
    v_xor_b32 v30, v30, v14
    v_xor_b32 v31, v31, v15
    v_or3_b32 v3, v3, v30, v31
    v_xor_b32 v34, v34, v14
    v_xor_b32 v35, v35, v15
    v_or3_b32 v3, v3, v34, v35
    v_xor_b32 v38, v38, v14
    v_xor_b32 v39, v39, v15
    v_or3_b32 v3, v3, v38, v39
    v_xor_b32 v42, v42, v14
    v_xor_b32 v43, v43, v15
    v_or3_b32 v3, v3, v42, v43
    v_xor_b32 v46, v46, v14
    v_xor_b32 v47, v47, v15
    v_or3_b32 v3, v3, v46, v47
    v_xor_b32 v50, v50, v14
    v_xor_b32 v51, v51, v15
    v_or3_b32 v3, v3, v50, v51
    v_xor_b32 v54, v54, v14
    v_xor_b32 v55, v55, v15
    v_or3_b32 v3, v3, v54, v55
    v_xor_b32 v58, v58, v14
    v_xor_b32 v59, v59, v15
    v_or3_b32 v3, v3, v58, v59
    v_xor_b32 v62, v62, v14
    v_xor_b32 v63, v63, v15
    v_or3_b32 v3, v3, v62, v63
    v_cmp_ne_u32 vcc, 0, v3
    s_add_u32 s16, s16, 1
    s_cmp_gt_u32 s16, 16384
    s_cbranch_scc1 L_gq_done
    s_cbranch_vccnz L_gq
L_gq_done:
    v_add_f32 v16, v16, v32
    v_add_f32 v17, v17, v33
    v_add_f32 v20, v20, v36
    v_add_f32 v21, v21, v37
    v_add_f32 v24, v24, v40
    v_add_f32 v25, v25, v41
    v_add_f32 v28, v28, v44
    v_add_f32 v29, v29, v45
    v_add_f32 v16, v16, v24
    v_add_f32 v17, v17, v25
    v_add_f32 v20, v20, v28
    v_add_f32 v21, v21, v29
    v_add_f32 v16, v16, v20
    v_add_f32 v17, v17, v21
    v_add_f32 v48, v48, v56
    v_add_f32 v49, v49, v57
    v_add_f32 v52, v52, v60
    v_add_f32 v53, v53, v61
    v_add_f32 v48, v48, v52
    v_add_f32 v49, v49, v53
    s_nop 1
    v_mov_b32 v3, v48
    s_nop 1
    v_permlane32_swap_b32 v3, v48
    s_nop 1
    v_add_f32 v48, v3, v48
    s_nop 1
    v_mov_b32 v3, v49
    s_nop 1
    v_permlane32_swap_b32 v3, v49
    s_nop 1
    v_add_f32 v49, v3, v49
    v_cvt_pk_bf16_f32 v16, v16, v17
    v_cvt_pk_bf16_f32 v48, v48, v49
    v_lshlrev_b32 v9, 2, v6
    ds_write_b32 v9, v16 offset:4608
    s_mov_b32 exec_hi, 0
    ds_write_b32 v9, v48 offset:4864
    s_mov_b64 exec, -1
    s_waitcnt lgkmcnt(0)
    v_mov_b32 v2, 0
    v_mov_b32 v3, 1
    s_mov_b64 exec, 1
    ds_add_u32 v2, v3 offset:7204
    s_mov_b64 exec, -1
L_vsvc_done:
    s_setprio 1
L_vrest:
    v_mov_b32 v16, 0
    v_mov_b32 v17, 0
    v_mov_b32 v18, 0
    v_mov_b32 v19, 0
    v_mov_b32 v20, 0
    v_mov_b32 v21, 0
    v_mov_b32 v22, 0
    v_mov_b32 v23, 0
    v_mov_b32 v24, 0
    v_mov_b32 v25, 0
    v_mov_b32 v26, 0
    v_mov_b32 v27, 0
    v_mov_b32 v28, 0
    v_mov_b32 v29, 0
    v_mov_b32 v30, 0
    v_mov_b32 v31, 0
    v_mov_b32 v32, 0
    v_mov_b32 v33, 0
    v_mov_b32 v34, 0
    v_mov_b32 v35, 0
    v_mov_b32 v36, 0
    v_mov_b32 v37, 0
    v_mov_b32 v38, 0
    v_mov_b32 v39, 0
    v_and_b32 v7, 7, v6
    v_lshlrev_b32 v7, 5, v7
    v_lshrrev_b32 v11, 5, v6
    v_lshlrev_b32 v11, 4, v11
    v_add_u32 v7, v7, v11
    v_bfe_u32 v11, v6, 4, 1
    v_lshlrev_b32 v11, 3, v11
    v_add_u32 v7, v7, v11
    s_sub_u32 s18, s5, 4
    s_mul_i32 s6, s18, 768
    v_add_u32 v7, s6, v7
    s_lshl_b32 s9, s18, 2
    v_mov_b32 v12, s9
    v_lshrrev_b32 v4, 3, v6
    v_lshlrev_b32 v4, 6, v4
    s_lshl_b32 s9, s18, 9
    v_add_u32 v4, s9, v4
    v_mov_b32 v11, v4
    v_lshrrev_b32 v2, 3, v6
    v_and_b32 v3, 7, v6
    v_lshlrev_b32 v3, 4, v3
    v_mul_u32_u24 v9, 1280, v2
    v_add_u32 v9, v9, v3
    v_mov_b32 v4, 1073741824
    v_cmp_gt_u32 vcc, 32, v6
    s_nop 1
    v_cndmask_b32 v10, v4, v9, vcc
    s_mul_i32 s6, s33, 640
    s_lshl_b32 s7, s5, 7
    s_add_u32 s6, s6, s7
    s_lshl_b32 s7, s3, 2
    s_add_u32 s7, s7, s32
    s_mul_i32 s14, s7, 61440
    s_add_u32 s14, s14, s6
    s_mul_i32 s15, s7, 15360
    s_add_u32 s15, s15, s6
    v_mov_b32 v4, v11
    s_cmp_eq_u32 s5, 4
    s_cselect_b32 s14, s14, 1073741824
    s_cselect_b32 s15, s15, 1073741824
    v_mov_b32 v2, 0
    s_mov_b32 s16, 0
L_sp5:
    ds_read_b32 v3, v2 offset:7228
    s_waitcnt lgkmcnt(0)
    v_readfirstlane_b32 s19, v3
    s_add_u32 s16, s16, 1
    s_cmp_ge_u32 s19, 4
    s_cbranch_scc1 L_spd5
    s_cmp_gt_u32 s16, 262144
    s_cbranch_scc1 L_spd5
    s_sleep 1
    s_branch L_sp5
L_spd5:
    s_waitcnt vmcnt(15)
    buffer_load_dwordx4 v[88:91], v1, s[48:51], s10 offen offset:0 nt
    s_waitcnt vmcnt(15)
    buffer_load_dwordx4 v[92:95], v1, s[48:51], s10 offen offset:128 nt
    s_waitcnt vmcnt(15)
    buffer_load_dwordx4 v[96:99], v1, s[48:51], s10 offen offset:256 nt
    s_add_u32 s10, s10, 3072
    s_sub_u32 s19, s10, 49152
    s_cmp_ge_u32 s10, s39
    s_cselect_b32 s10, s19, s10
    s_waitcnt vmcnt(15)
    buffer_load_dwordx4 v[100:103], v1, s[48:51], s10 offen offset:0 nt
    s_waitcnt vmcnt(15)
    buffer_load_dwordx4 v[104:107], v1, s[48:51], s10 offen offset:128 nt
    s_waitcnt vmcnt(15)
    buffer_load_dwordx4 v[108:111], v1, s[48:51], s10 offen offset:256 nt
    s_add_u32 s10, s10, 3072
    s_sub_u32 s19, s10, 49152
    s_cmp_ge_u32 s10, s39
    s_cselect_b32 s10, s19, s10
    s_waitcnt vmcnt(15)
    buffer_load_dwordx4 v[112:115], v1, s[48:51], s10 offen offset:0 nt
    s_waitcnt vmcnt(15)
    buffer_load_dwordx4 v[116:119], v1, s[48:51], s10 offen offset:128 nt
    s_waitcnt vmcnt(15)
    buffer_load_dwordx4 v[120:123], v1, s[48:51], s10 offen offset:256 nt
    s_add_u32 s10, s10, 3072
    s_sub_u32 s19, s10, 49152
    s_cmp_ge_u32 s10, s39
    s_cselect_b32 s10, s19, s10
    s_waitcnt vmcnt(15)
    buffer_load_dwordx4 v[124:127], v1, s[48:51], s10 offen offset:0 nt
    s_waitcnt vmcnt(15)
    buffer_load_dwordx4 v[128:131], v1, s[48:51], s10 offen offset:128 nt
    s_waitcnt vmcnt(15)
    buffer_load_dwordx4 v[132:135], v1, s[48:51], s10 offen offset:256 nt
    s_add_u32 s10, s10, 3072
    s_sub_u32 s19, s10, 49152
    s_cmp_ge_u32 s10, s39
    s_cselect_b32 s10, s19, s10
    s_waitcnt vmcnt(15)
    buffer_load_dwordx4 v[136:139], v1, s[48:51], s10 offen offset:0 nt
    s_waitcnt vmcnt(15)
    buffer_load_dwordx4 v[140:143], v1, s[48:51], s10 offen offset:128 nt
    s_waitcnt vmcnt(15)
    buffer_load_dwordx4 v[144:147], v1, s[48:51], s10 offen offset:256 nt
    s_add_u32 s10, s10, 3072
    s_sub_u32 s19, s10, 49152
    s_cmp_ge_u32 s10, s39
    s_cselect_b32 s10, s19, s10
    s_waitcnt vmcnt(15)
    buffer_load_dwordx4 v[148:151], v1, s[48:51], s10 offen offset:0 nt
    s_waitcnt vmcnt(15)
    buffer_load_dwordx4 v[152:155], v1, s[48:51], s10 offen offset:128 nt
    s_waitcnt vmcnt(15)
    buffer_load_dwordx4 v[156:159], v1, s[48:51], s10 offen offset:256 nt
    s_add_u32 s10, s10, 3072
    s_sub_u32 s19, s10, 49152
    s_cmp_ge_u32 s10, s39
    s_cselect_b32 s10, s19, s10
    s_mov_b32 s16, 0
L_sp6:
    ds_read_b32 v3, v12 offset:7232
    s_waitcnt lgkmcnt(0)
    v_readfirstlane_b32 s19, v3
    s_add_u32 s16, s16, 1
    s_cmp_ge_u32 s19, 1
    s_cbranch_scc1 L_spd6
    s_cmp_gt_u32 s16, 262144
    s_cbranch_scc1 L_spd6
    s_sleep 1
    s_branch L_sp6
L_spd6:
    ds_read_b128 v[40:43], v4 offset:5120
    ds_read_b128 v[44:47], v4 offset:5136
    ds_read_b128 v[48:51], v4 offset:5152
    ds_read_b128 v[52:55], v4 offset:5168
    v_mov_b32 v2, 0
    ds_read_b64 v[14:15], v2 offset:7296
    s_waitcnt lgkmcnt(0)
    s_waitcnt vmcnt(15)
    buffer_load_dwordx4 v[160:163], v1, s[48:51], s10 offen offset:0 nt
    s_waitcnt vmcnt(15)
    buffer_load_dwordx4 v[164:167], v1, s[48:51], s10 offen offset:128 nt
    s_waitcnt vmcnt(15)
    buffer_load_dwordx4 v[168:171], v1, s[48:51], s10 offen offset:256 nt
    s_add_u32 s10, s10, 3072
    s_sub_u32 s19, s10, 49152
    s_cmp_ge_u32 s10, s39
    s_cselect_b32 s10, s19, s10
    v_lshlrev_b32 v2, 16, v40
    v_dot2c_f32_bf16 v16, v64, v40
    v_dot2c_f32_bf16 v17, v64, v2
    v_dot2c_f32_bf16 v18, v65, v40
    v_dot2c_f32_bf16 v19, v65, v2
    v_dot2c_f32_bf16 v20, v66, v40
    v_dot2c_f32_bf16 v21, v66, v2
    v_dot2c_f32_bf16 v22, v67, v40
    v_dot2c_f32_bf16 v23, v67, v2
    v_dot2c_f32_bf16 v24, v68, v40
    v_dot2c_f32_bf16 v25, v68, v2
    v_dot2c_f32_bf16 v26, v69, v40
    v_dot2c_f32_bf16 v27, v69, v2
    v_dot2c_f32_bf16 v28, v70, v40
    v_dot2c_f32_bf16 v29, v70, v2
    v_dot2c_f32_bf16 v30, v71, v40
    v_dot2c_f32_bf16 v31, v71, v2
    v_dot2c_f32_bf16 v32, v72, v40
    v_dot2c_f32_bf16 v33, v72, v2
    v_dot2c_f32_bf16 v34, v73, v40
    v_dot2c_f32_bf16 v35, v73, v2
    v_dot2c_f32_bf16 v36, v74, v40
    v_dot2c_f32_bf16 v37, v74, v2
    v_dot2c_f32_bf16 v38, v75, v40
    v_dot2c_f32_bf16 v39, v75, v2
    v_lshlrev_b32 v3, 16, v41
    v_dot2c_f32_bf16 v16, v76, v41
    v_dot2c_f32_bf16 v17, v76, v3
    v_dot2c_f32_bf16 v18, v77, v41
    v_dot2c_f32_bf16 v19, v77, v3
    v_dot2c_f32_bf16 v20, v78, v41
    v_dot2c_f32_bf16 v21, v78, v3
    v_dot2c_f32_bf16 v22, v79, v41
    v_dot2c_f32_bf16 v23, v79, v3
    v_dot2c_f32_bf16 v24, v80, v41
    v_dot2c_f32_bf16 v25, v80, v3
    v_dot2c_f32_bf16 v26, v81, v41
    v_dot2c_f32_bf16 v27, v81, v3
    v_dot2c_f32_bf16 v28, v82, v41
    v_dot2c_f32_bf16 v29, v82, v3
    v_dot2c_f32_bf16 v30, v83, v41
    v_dot2c_f32_bf16 v31, v83, v3
    v_dot2c_f32_bf16 v32, v84, v41
    v_dot2c_f32_bf16 v33, v84, v3
    v_dot2c_f32_bf16 v34, v85, v41
    v_dot2c_f32_bf16 v35, v85, v3
    v_dot2c_f32_bf16 v36, v86, v41
    v_dot2c_f32_bf16 v37, v86, v3
    v_dot2c_f32_bf16 v38, v87, v41
    v_dot2c_f32_bf16 v39, v87, v3
    s_waitcnt vmcnt(15)
    buffer_load_dwordx4 v[172:175], v1, s[48:51], s10 offen offset:0 nt
    s_waitcnt vmcnt(15)
    buffer_load_dwordx4 v[176:179], v1, s[48:51], s10 offen offset:128 nt
    s_waitcnt vmcnt(15)
    buffer_load_dwordx4 v[180:183], v1, s[48:51], s10 offen offset:256 nt
    s_add_u32 s10, s10, 3072
    s_sub_u32 s19, s10, 49152
    s_cmp_ge_u32 s10, s39
    s_cselect_b32 s10, s19, s10
    v_lshlrev_b32 v2, 16, v42
    v_dot2c_f32_bf16 v16, v88, v42
    v_dot2c_f32_bf16 v17, v88, v2
    v_dot2c_f32_bf16 v18, v89, v42
    v_dot2c_f32_bf16 v19, v89, v2
    v_dot2c_f32_bf16 v20, v90, v42
    v_dot2c_f32_bf16 v21, v90, v2
    v_dot2c_f32_bf16 v22, v91, v42
    v_dot2c_f32_bf16 v23, v91, v2
    v_dot2c_f32_bf16 v24, v92, v42
    v_dot2c_f32_bf16 v25, v92, v2
    v_dot2c_f32_bf16 v26, v93, v42
    v_dot2c_f32_bf16 v27, v93, v2
    v_dot2c_f32_bf16 v28, v94, v42
    v_dot2c_f32_bf16 v29, v94, v2
    v_dot2c_f32_bf16 v30, v95, v42
    v_dot2c_f32_bf16 v31, v95, v2
    v_dot2c_f32_bf16 v32, v96, v42
    v_dot2c_f32_bf16 v33, v96, v2
    v_dot2c_f32_bf16 v34, v97, v42
    v_dot2c_f32_bf16 v35, v97, v2
    v_dot2c_f32_bf16 v36, v98, v42
    v_dot2c_f32_bf16 v37, v98, v2
    v_dot2c_f32_bf16 v38, v99, v42
    v_dot2c_f32_bf16 v39, v99, v2
    v_lshlrev_b32 v3, 16, v43
    v_dot2c_f32_bf16 v16, v100, v43
    v_dot2c_f32_bf16 v17, v100, v3
    v_dot2c_f32_bf16 v18, v101, v43
    v_dot2c_f32_bf16 v19, v101, v3
    v_dot2c_f32_bf16 v20, v102, v43
    v_dot2c_f32_bf16 v21, v102, v3
    v_dot2c_f32_bf16 v22, v103, v43
    v_dot2c_f32_bf16 v23, v103, v3
    v_dot2c_f32_bf16 v24, v104, v43
    v_dot2c_f32_bf16 v25, v104, v3
    v_dot2c_f32_bf16 v26, v105, v43
    v_dot2c_f32_bf16 v27, v105, v3
    v_dot2c_f32_bf16 v28, v106, v43
    v_dot2c_f32_bf16 v29, v106, v3
    v_dot2c_f32_bf16 v30, v107, v43
    v_dot2c_f32_bf16 v31, v107, v3
    v_dot2c_f32_bf16 v32, v108, v43
    v_dot2c_f32_bf16 v33, v108, v3
    v_dot2c_f32_bf16 v34, v109, v43
    v_dot2c_f32_bf16 v35, v109, v3
    v_dot2c_f32_bf16 v36, v110, v43
    v_dot2c_f32_bf16 v37, v110, v3
    v_dot2c_f32_bf16 v38, v111, v43
    v_dot2c_f32_bf16 v39, v111, v3
    s_waitcnt vmcnt(15)
    buffer_load_dwordx4 v[184:187], v1, s[48:51], s10 offen offset:0 nt
    s_waitcnt vmcnt(15)
    buffer_load_dwordx4 v[188:191], v1, s[48:51], s10 offen offset:128 nt
    s_waitcnt vmcnt(15)
    buffer_load_dwordx4 v[192:195], v1, s[48:51], s10 offen offset:256 nt
    s_add_u32 s10, s10, 3072
    s_sub_u32 s19, s10, 49152
    s_cmp_ge_u32 s10, s39
    s_cselect_b32 s10, s19, s10
    v_lshlrev_b32 v2, 16, v44
    v_dot2c_f32_bf16 v16, v112, v44
    v_dot2c_f32_bf16 v17, v112, v2
    v_dot2c_f32_bf16 v18, v113, v44
    v_dot2c_f32_bf16 v19, v113, v2
    v_dot2c_f32_bf16 v20, v114, v44
    v_dot2c_f32_bf16 v21, v114, v2
    v_dot2c_f32_bf16 v22, v115, v44
    v_dot2c_f32_bf16 v23, v115, v2
    v_dot2c_f32_bf16 v24, v116, v44
    v_dot2c_f32_bf16 v25, v116, v2
    v_dot2c_f32_bf16 v26, v117, v44
    v_dot2c_f32_bf16 v27, v117, v2
    v_dot2c_f32_bf16 v28, v118, v44
    v_dot2c_f32_bf16 v29, v118, v2
    v_dot2c_f32_bf16 v30, v119, v44
    v_dot2c_f32_bf16 v31, v119, v2
    v_dot2c_f32_bf16 v32, v120, v44
    v_dot2c_f32_bf16 v33, v120, v2
    v_dot2c_f32_bf16 v34, v121, v44
    v_dot2c_f32_bf16 v35, v121, v2
    v_dot2c_f32_bf16 v36, v122, v44
    v_dot2c_f32_bf16 v37, v122, v2
    v_dot2c_f32_bf16 v38, v123, v44
    v_dot2c_f32_bf16 v39, v123, v2
    s_waitcnt vmcnt(15)
    v_lshlrev_b32 v3, 16, v45
    v_dot2c_f32_bf16 v16, v124, v45
    v_dot2c_f32_bf16 v17, v124, v3
    v_dot2c_f32_bf16 v18, v125, v45
    v_dot2c_f32_bf16 v19, v125, v3
    v_dot2c_f32_bf16 v20, v126, v45
    v_dot2c_f32_bf16 v21, v126, v3
    v_dot2c_f32_bf16 v22, v127, v45
    v_dot2c_f32_bf16 v23, v127, v3
    v_dot2c_f32_bf16 v24, v128, v45
    v_dot2c_f32_bf16 v25, v128, v3
    v_dot2c_f32_bf16 v26, v129, v45
    v_dot2c_f32_bf16 v27, v129, v3
    v_dot2c_f32_bf16 v28, v130, v45
    v_dot2c_f32_bf16 v29, v130, v3
    v_dot2c_f32_bf16 v30, v131, v45
    v_dot2c_f32_bf16 v31, v131, v3
    v_dot2c_f32_bf16 v32, v132, v45
    v_dot2c_f32_bf16 v33, v132, v3
    v_dot2c_f32_bf16 v34, v133, v45
    v_dot2c_f32_bf16 v35, v133, v3
    v_dot2c_f32_bf16 v36, v134, v45
    v_dot2c_f32_bf16 v37, v134, v3
    v_dot2c_f32_bf16 v38, v135, v45
    v_dot2c_f32_bf16 v39, v135, v3
    s_waitcnt vmcnt(15)
    buffer_load_dwordx4 v[196:199], v1, s[48:51], s10 offen offset:0 nt
    s_waitcnt vmcnt(15)
    buffer_load_dwordx4 v[200:203], v1, s[48:51], s10 offen offset:128 nt
    s_waitcnt vmcnt(15)
    buffer_load_dwordx4 v[204:207], v1, s[48:51], s10 offen offset:256 nt
    s_add_u32 s10, s10, 3072
    s_sub_u32 s19, s10, 49152
    s_cmp_ge_u32 s10, s39
    s_cselect_b32 s10, s19, s10
    s_waitcnt vmcnt(15)
    v_lshlrev_b32 v2, 16, v46
    v_dot2c_f32_bf16 v16, v136, v46
    v_dot2c_f32_bf16 v17, v136, v2
    v_dot2c_f32_bf16 v18, v137, v46
    v_dot2c_f32_bf16 v19, v137, v2
    v_dot2c_f32_bf16 v20, v138, v46
    v_dot2c_f32_bf16 v21, v138, v2
    v_dot2c_f32_bf16 v22, v139, v46
    v_dot2c_f32_bf16 v23, v139, v2
    v_dot2c_f32_bf16 v24, v140, v46
    v_dot2c_f32_bf16 v25, v140, v2
    v_dot2c_f32_bf16 v26, v141, v46
    v_dot2c_f32_bf16 v27, v141, v2
    v_dot2c_f32_bf16 v28, v142, v46
    v_dot2c_f32_bf16 v29, v142, v2
    v_dot2c_f32_bf16 v30, v143, v46
    v_dot2c_f32_bf16 v31, v143, v2
    v_dot2c_f32_bf16 v32, v144, v46
    v_dot2c_f32_bf16 v33, v144, v2
    v_dot2c_f32_bf16 v34, v145, v46
    v_dot2c_f32_bf16 v35, v145, v2
    v_dot2c_f32_bf16 v36, v146, v46
    v_dot2c_f32_bf16 v37, v146, v2
    v_dot2c_f32_bf16 v38, v147, v46
    v_dot2c_f32_bf16 v39, v147, v2
    s_waitcnt vmcnt(12)
    v_lshlrev_b32 v3, 16, v47
    v_dot2c_f32_bf16 v16, v148, v47
    v_dot2c_f32_bf16 v17, v148, v3
    v_dot2c_f32_bf16 v18, v149, v47
    v_dot2c_f32_bf16 v19, v149, v3
    v_dot2c_f32_bf16 v20, v150, v47
    v_dot2c_f32_bf16 v21, v150, v3
    v_dot2c_f32_bf16 v22, v151, v47
    v_dot2c_f32_bf16 v23, v151, v3
    v_dot2c_f32_bf16 v24, v152, v47
    v_dot2c_f32_bf16 v25, v152, v3
    v_dot2c_f32_bf16 v26, v153, v47
    v_dot2c_f32_bf16 v27, v153, v3
    v_dot2c_f32_bf16 v28, v154, v47
    v_dot2c_f32_bf16 v29, v154, v3
    v_dot2c_f32_bf16 v30, v155, v47
    v_dot2c_f32_bf16 v31, v155, v3
    v_dot2c_f32_bf16 v32, v156, v47
    v_dot2c_f32_bf16 v33, v156, v3
    v_dot2c_f32_bf16 v34, v157, v47
    v_dot2c_f32_bf16 v35, v157, v3
    v_dot2c_f32_bf16 v36, v158, v47
    v_dot2c_f32_bf16 v37, v158, v3
    v_dot2c_f32_bf16 v38, v159, v47
    v_dot2c_f32_bf16 v39, v159, v3
    s_waitcnt vmcnt(15)
    buffer_load_dwordx4 v[208:211], v1, s[48:51], s10 offen offset:0 nt
    s_waitcnt vmcnt(15)
    buffer_load_dwordx4 v[212:215], v1, s[48:51], s10 offen offset:128 nt
    s_waitcnt vmcnt(15)
    buffer_load_dwordx4 v[216:219], v1, s[48:51], s10 offen offset:256 nt
    s_add_u32 s10, s10, 3072
    s_sub_u32 s19, s10, 49152
    s_cmp_ge_u32 s10, s39
    s_cselect_b32 s10, s19, s10
    s_waitcnt vmcnt(12)
    v_lshlrev_b32 v2, 16, v48
    v_dot2c_f32_bf16 v16, v160, v48
    v_dot2c_f32_bf16 v17, v160, v2
    v_dot2c_f32_bf16 v18, v161, v48
    v_dot2c_f32_bf16 v19, v161, v2
    v_dot2c_f32_bf16 v20, v162, v48
    v_dot2c_f32_bf16 v21, v162, v2
    v_dot2c_f32_bf16 v22, v163, v48
    v_dot2c_f32_bf16 v23, v163, v2
    v_dot2c_f32_bf16 v24, v164, v48
    v_dot2c_f32_bf16 v25, v164, v2
    v_dot2c_f32_bf16 v26, v165, v48
    v_dot2c_f32_bf16 v27, v165, v2
    v_dot2c_f32_bf16 v28, v166, v48
    v_dot2c_f32_bf16 v29, v166, v2
    v_dot2c_f32_bf16 v30, v167, v48
    v_dot2c_f32_bf16 v31, v167, v2
    v_dot2c_f32_bf16 v32, v168, v48
    v_dot2c_f32_bf16 v33, v168, v2
    v_dot2c_f32_bf16 v34, v169, v48
    v_dot2c_f32_bf16 v35, v169, v2
    v_dot2c_f32_bf16 v36, v170, v48
    v_dot2c_f32_bf16 v37, v170, v2
    v_dot2c_f32_bf16 v38, v171, v48
    v_dot2c_f32_bf16 v39, v171, v2
    s_waitcnt vmcnt(9)
    v_lshlrev_b32 v3, 16, v49
    v_dot2c_f32_bf16 v16, v172, v49
    v_dot2c_f32_bf16 v17, v172, v3
    v_dot2c_f32_bf16 v18, v173, v49
    v_dot2c_f32_bf16 v19, v173, v3
    v_dot2c_f32_bf16 v20, v174, v49
    v_dot2c_f32_bf16 v21, v174, v3
    v_dot2c_f32_bf16 v22, v175, v49
    v_dot2c_f32_bf16 v23, v175, v3
    v_dot2c_f32_bf16 v24, v176, v49
    v_dot2c_f32_bf16 v25, v176, v3
    v_dot2c_f32_bf16 v26, v177, v49
    v_dot2c_f32_bf16 v27, v177, v3
    v_dot2c_f32_bf16 v28, v178, v49
    v_dot2c_f32_bf16 v29, v178, v3
    v_dot2c_f32_bf16 v30, v179, v49
    v_dot2c_f32_bf16 v31, v179, v3
    v_dot2c_f32_bf16 v32, v180, v49
    v_dot2c_f32_bf16 v33, v180, v3
    v_dot2c_f32_bf16 v34, v181, v49
    v_dot2c_f32_bf16 v35, v181, v3
    v_dot2c_f32_bf16 v36, v182, v49
    v_dot2c_f32_bf16 v37, v182, v3
    v_dot2c_f32_bf16 v38, v183, v49
    v_dot2c_f32_bf16 v39, v183, v3
    buffer_load_dwordx4 v[88:91], v9, s[68:71], s15 offen nt
    s_add_u32 s15, s15, 10240
    buffer_load_dwordx4 v[92:95], v10, s[68:71], s15 offen nt
    buffer_load_dwordx4 v[64:67], v9, s[56:59], s14 offen nt
    s_add_u32 s14, s14, 10240
    buffer_load_dwordx4 v[68:71], v9, s[56:59], s14 offen nt
    s_add_u32 s14, s14, 10240
    buffer_load_dwordx4 v[72:75], v9, s[56:59], s14 offen nt
    s_add_u32 s14, s14, 10240
    buffer_load_dwordx4 v[76:79], v9, s[56:59], s14 offen nt
    s_add_u32 s14, s14, 10240
    buffer_load_dwordx4 v[80:83], v9, s[56:59], s14 offen nt
    s_add_u32 s14, s14, 10240
    buffer_load_dwordx4 v[84:87], v9, s[56:59], s14 offen nt
    s_waitcnt vmcnt(15)
    buffer_load_dwordx4 v[220:223], v1, s[48:51], s10 offen offset:0 nt
    s_waitcnt vmcnt(15)
    buffer_load_dwordx4 v[224:227], v1, s[48:51], s10 offen offset:128 nt
    s_waitcnt vmcnt(15)
    buffer_load_dwordx4 v[228:231], v1, s[48:51], s10 offen offset:256 nt
    s_add_u32 s10, s10, 3072
    s_sub_u32 s19, s10, 49152
    s_cmp_ge_u32 s10, s39
    s_cselect_b32 s10, s19, s10
    v_lshlrev_b32 v2, 16, v50
    v_dot2c_f32_bf16 v16, v184, v50
    v_dot2c_f32_bf16 v17, v184, v2
    v_dot2c_f32_bf16 v18, v185, v50
    v_dot2c_f32_bf16 v19, v185, v2
    v_dot2c_f32_bf16 v20, v186, v50
    v_dot2c_f32_bf16 v21, v186, v2
    v_dot2c_f32_bf16 v22, v187, v50
    v_dot2c_f32_bf16 v23, v187, v2
    v_dot2c_f32_bf16 v24, v188, v50
    v_dot2c_f32_bf16 v25, v188, v2
    v_dot2c_f32_bf16 v26, v189, v50
    v_dot2c_f32_bf16 v27, v189, v2
    v_dot2c_f32_bf16 v28, v190, v50
    v_dot2c_f32_bf16 v29, v190, v2
    v_dot2c_f32_bf16 v30, v191, v50
    v_dot2c_f32_bf16 v31, v191, v2
    v_dot2c_f32_bf16 v32, v192, v50
    v_dot2c_f32_bf16 v33, v192, v2
    v_dot2c_f32_bf16 v34, v193, v50
    v_dot2c_f32_bf16 v35, v193, v2
    v_dot2c_f32_bf16 v36, v194, v50
    v_dot2c_f32_bf16 v37, v194, v2
    v_dot2c_f32_bf16 v38, v195, v50
    v_dot2c_f32_bf16 v39, v195, v2
    s_nop 2
    v_mov_b32 v2, 0
    s_mov_b32 s16, 0
L_sp7:
    ds_read_b32 v3, v2 offset:7208
    s_waitcnt lgkmcnt(0)
    v_readfirstlane_b32 s19, v3
    s_add_u32 s16, s16, 1
    s_cmp_ge_u32 s19, 4
    s_cbranch_scc1 L_spd7
    s_cmp_gt_u32 s16, 262144
    s_cbranch_scc1 L_spd7
    s_sleep 1
    s_branch L_sp7
L_spd7:
    ds_read_b128 v[56:59], v2 offset:7168
    ds_read_b32 v8, v12 offset:7168
    s_waitcnt lgkmcnt(0)
    v_max3_f32 v56, v56, v57, v58
    v_max_f32 v56, v56, v59
    v_sub_f32 v8, v8, v56
    v_mul_f32 v8, 0x3fb8aa3b, v8
    v_exp_f32 v8, v8
    s_nop 0
    s_waitcnt vmcnt(15)
    buffer_load_dwordx4 v[232:235], v1, s[48:51], s10 offen offset:0 nt
    s_waitcnt vmcnt(15)
    buffer_load_dwordx4 v[236:239], v1, s[48:51], s10 offen offset:128 nt
    s_waitcnt vmcnt(15)
    buffer_load_dwordx4 v[240:243], v1, s[48:51], s10 offen offset:256 nt
    s_add_u32 s10, s10, 3072
    s_sub_u32 s19, s10, 49152
    s_cmp_ge_u32 s10, s39
    s_cselect_b32 s10, s19, s10
    v_lshlrev_b32 v3, 16, v51
    v_dot2c_f32_bf16 v16, v196, v51
    v_dot2c_f32_bf16 v17, v196, v3
    v_dot2c_f32_bf16 v18, v197, v51
    v_dot2c_f32_bf16 v19, v197, v3
    v_dot2c_f32_bf16 v20, v198, v51
    v_dot2c_f32_bf16 v21, v198, v3
    v_dot2c_f32_bf16 v22, v199, v51
    v_dot2c_f32_bf16 v23, v199, v3
    v_dot2c_f32_bf16 v24, v200, v51
    v_dot2c_f32_bf16 v25, v200, v3
    v_dot2c_f32_bf16 v26, v201, v51
    v_dot2c_f32_bf16 v27, v201, v3
    v_dot2c_f32_bf16 v28, v202, v51
    v_dot2c_f32_bf16 v29, v202, v3
    v_dot2c_f32_bf16 v30, v203, v51
    v_dot2c_f32_bf16 v31, v203, v3
    v_dot2c_f32_bf16 v32, v204, v51
    v_dot2c_f32_bf16 v33, v204, v3
    v_dot2c_f32_bf16 v34, v205, v51
    v_dot2c_f32_bf16 v35, v205, v3
    v_dot2c_f32_bf16 v36, v206, v51
    v_dot2c_f32_bf16 v37, v206, v3
    v_dot2c_f32_bf16 v38, v207, v51
    v_dot2c_f32_bf16 v39, v207, v3
    s_waitcnt vmcnt(15)
    buffer_load_dwordx4 v[244:247], v1, s[48:51], s10 offen offset:0 nt
    s_waitcnt vmcnt(15)
    buffer_load_dwordx4 v[248:251], v1, s[48:51], s10 offen offset:128 nt
    s_waitcnt vmcnt(15)
    buffer_load_dwordx4 v[252:255], v1, s[48:51], s10 offen offset:256 nt
    s_add_u32 s10, s10, 3072
    s_sub_u32 s19, s10, 49152
    s_cmp_ge_u32 s10, s39
    s_cselect_b32 s10, s19, s10
    v_lshlrev_b32 v2, 16, v52
    v_dot2c_f32_bf16 v16, v208, v52
    v_dot2c_f32_bf16 v17, v208, v2
    v_dot2c_f32_bf16 v18, v209, v52
    v_dot2c_f32_bf16 v19, v209, v2
    v_dot2c_f32_bf16 v20, v210, v52
    v_dot2c_f32_bf16 v21, v210, v2
    v_dot2c_f32_bf16 v22, v211, v52
    v_dot2c_f32_bf16 v23, v211, v2
    v_dot2c_f32_bf16 v24, v212, v52
    v_dot2c_f32_bf16 v25, v212, v2
    v_dot2c_f32_bf16 v26, v213, v52
    v_dot2c_f32_bf16 v27, v213, v2
    v_dot2c_f32_bf16 v28, v214, v52
    v_dot2c_f32_bf16 v29, v214, v2
    v_dot2c_f32_bf16 v30, v215, v52
    v_dot2c_f32_bf16 v31, v215, v2
    v_dot2c_f32_bf16 v32, v216, v52
    v_dot2c_f32_bf16 v33, v216, v2
    v_dot2c_f32_bf16 v34, v217, v52
    v_dot2c_f32_bf16 v35, v217, v2
    v_dot2c_f32_bf16 v36, v218, v52
    v_dot2c_f32_bf16 v37, v218, v2
    v_dot2c_f32_bf16 v38, v219, v52
    v_dot2c_f32_bf16 v39, v219, v2
    s_nop 2
    s_waitcnt lgkmcnt(0)
    v_mov_b32 v2, 0
    v_mov_b32 v3, 1
    s_mov_b64 exec, 1
    ds_add_u32 v2, v3 offset:7224
    s_mov_b64 exec, -1
    s_setprio 3
    s_waitcnt vmcnt(6)
    v_lshlrev_b32 v3, 16, v53
    v_dot2c_f32_bf16 v16, v220, v53
    v_dot2c_f32_bf16 v17, v220, v3
    v_dot2c_f32_bf16 v18, v221, v53
    v_dot2c_f32_bf16 v19, v221, v3
    v_dot2c_f32_bf16 v20, v222, v53
    v_dot2c_f32_bf16 v21, v222, v3
    v_dot2c_f32_bf16 v22, v223, v53
    v_dot2c_f32_bf16 v23, v223, v3
    v_dot2c_f32_bf16 v24, v224, v53
    v_dot2c_f32_bf16 v25, v224, v3
    v_dot2c_f32_bf16 v26, v225, v53
    v_dot2c_f32_bf16 v27, v225, v3
    v_dot2c_f32_bf16 v28, v226, v53
    v_dot2c_f32_bf16 v29, v226, v3
    v_dot2c_f32_bf16 v30, v227, v53
    v_dot2c_f32_bf16 v31, v227, v3
    v_dot2c_f32_bf16 v32, v228, v53
    v_dot2c_f32_bf16 v33, v228, v3
    v_dot2c_f32_bf16 v34, v229, v53
    v_dot2c_f32_bf16 v35, v229, v3
    v_dot2c_f32_bf16 v36, v230, v53
    v_dot2c_f32_bf16 v37, v230, v3
    v_dot2c_f32_bf16 v38, v231, v53
    v_dot2c_f32_bf16 v39, v231, v3
    s_waitcnt vmcnt(3)
    v_lshlrev_b32 v2, 16, v54
    v_dot2c_f32_bf16 v16, v232, v54
    v_dot2c_f32_bf16 v17, v232, v2
    v_dot2c_f32_bf16 v18, v233, v54
    v_dot2c_f32_bf16 v19, v233, v2
    v_dot2c_f32_bf16 v20, v234, v54
    v_dot2c_f32_bf16 v21, v234, v2
    v_dot2c_f32_bf16 v22, v235, v54
    v_dot2c_f32_bf16 v23, v235, v2
    v_dot2c_f32_bf16 v24, v236, v54
    v_dot2c_f32_bf16 v25, v236, v2
    v_dot2c_f32_bf16 v26, v237, v54
    v_dot2c_f32_bf16 v27, v237, v2
    v_dot2c_f32_bf16 v28, v238, v54
    v_dot2c_f32_bf16 v29, v238, v2
    v_dot2c_f32_bf16 v30, v239, v54
    v_dot2c_f32_bf16 v31, v239, v2
    v_dot2c_f32_bf16 v32, v240, v54
    v_dot2c_f32_bf16 v33, v240, v2
    v_dot2c_f32_bf16 v34, v241, v54
    v_dot2c_f32_bf16 v35, v241, v2
    v_dot2c_f32_bf16 v36, v242, v54
    v_dot2c_f32_bf16 v37, v242, v2
    v_dot2c_f32_bf16 v38, v243, v54
    v_dot2c_f32_bf16 v39, v243, v2
    s_waitcnt vmcnt(0)
    v_lshlrev_b32 v3, 16, v55
    v_dot2c_f32_bf16 v16, v244, v55
    v_dot2c_f32_bf16 v17, v244, v3
    v_dot2c_f32_bf16 v18, v245, v55
    v_dot2c_f32_bf16 v19, v245, v3
    v_dot2c_f32_bf16 v20, v246, v55
    v_dot2c_f32_bf16 v21, v246, v3
    v_dot2c_f32_bf16 v22, v247, v55
    v_dot2c_f32_bf16 v23, v247, v3
    v_dot2c_f32_bf16 v24, v248, v55
    v_dot2c_f32_bf16 v25, v248, v3
    v_dot2c_f32_bf16 v26, v249, v55
    v_dot2c_f32_bf16 v27, v249, v3
    v_dot2c_f32_bf16 v28, v250, v55
    v_dot2c_f32_bf16 v29, v250, v3
    v_dot2c_f32_bf16 v30, v251, v55
    v_dot2c_f32_bf16 v31, v251, v3
    v_dot2c_f32_bf16 v32, v252, v55
    v_dot2c_f32_bf16 v33, v252, v3
    v_dot2c_f32_bf16 v34, v253, v55
    v_dot2c_f32_bf16 v35, v253, v3
    v_dot2c_f32_bf16 v36, v254, v55
    v_dot2c_f32_bf16 v37, v254, v3
    v_dot2c_f32_bf16 v38, v255, v55
    v_dot2c_f32_bf16 v39, v255, v3
    s_nop 2
    v_permlane32_swap_b32 v16, v20
    v_permlane32_swap_b32 v17, v21
    v_permlane32_swap_b32 v18, v22
    v_permlane32_swap_b32 v19, v23
    v_permlane32_swap_b32 v24, v28
    v_permlane32_swap_b32 v25, v29
    v_permlane32_swap_b32 v26, v30
    v_permlane32_swap_b32 v27, v31
    v_permlane32_swap_b32 v32, v36
    v_permlane32_swap_b32 v33, v37
    v_permlane32_swap_b32 v34, v38
    v_permlane32_swap_b32 v35, v39
    s_nop 1
    v_add_f32 v16, v16, v20
    v_add_f32 v17, v17, v21
    v_add_f32 v18, v18, v22
    v_add_f32 v19, v19, v23
    v_add_f32 v24, v24, v28
    v_add_f32 v25, v25, v29
    v_add_f32 v26, v26, v30
    v_add_f32 v27, v27, v31
    v_add_f32 v32, v32, v36
    v_add_f32 v33, v33, v37
    v_add_f32 v34, v34, v38
    v_add_f32 v35, v35, v39
    s_nop 1
    v_permlane16_swap_b32 v16, v18
    v_permlane16_swap_b32 v17, v19
    v_permlane16_swap_b32 v24, v26
    v_permlane16_swap_b32 v25, v27
    v_permlane16_swap_b32 v32, v34
    v_permlane16_swap_b32 v33, v35
    s_nop 1
    v_add_f32 v16, v16, v18
    v_add_f32 v17, v17, v19
    v_add_f32 v24, v24, v26
    v_add_f32 v25, v25, v27
    v_add_f32 v32, v32, v34
    v_add_f32 v33, v33, v35
    s_nop 1
    v_add_f32 v16, v16, v16 row_ror:8 row_mask:0xf bank_mask:0xf
    v_add_f32 v17, v17, v17 row_ror:8 row_mask:0xf bank_mask:0xf
    v_add_f32 v24, v24, v24 row_ror:8 row_mask:0xf bank_mask:0xf
    v_add_f32 v25, v25, v25 row_ror:8 row_mask:0xf bank_mask:0xf
    v_add_f32 v32, v32, v32 row_ror:8 row_mask:0xf bank_mask:0xf
    v_add_f32 v33, v33, v33 row_ror:8 row_mask:0xf bank_mask:0xf
    v_mul_f32 v16, v8, v16
    v_mul_f32 v17, v8, v17
    v_mul_f32 v24, v8, v24
    v_mul_f32 v25, v8, v25
    v_mul_f32 v32, v8, v32
    v_mul_f32 v33, v8, v33
    ds_write_b64 v7, v[16:17] offset:0
    ds_write_b64 v7, v[24:25] offset:256
    ds_write_b64 v7, v[32:33] offset:512
    s_waitcnt lgkmcnt(0)
    v_mov_b32 v2, 0
    v_mov_b32 v3, 1
    s_mov_b64 exec, 1
    ds_add_u32 v2, v3 offset:7220
    s_mov_b64 exec, -1
    s_cmp_eq_u32 s5, 4
    s_cbranch_scc1 L_stagec
    s_cmp_eq_u32 s5, 6
    s_cbranch_scc1 L_merge
    s_cmp_eq_u32 s5, 7
    s_cbranch_scc1 L_final
    v_mov_b32 v2, 0
    s_mov_b32 s16, 0
L_sp8:
    ds_read_b32 v3, v2 offset:7220
    s_waitcnt lgkmcnt(0)
    v_readfirstlane_b32 s19, v3
    s_add_u32 s16, s16, 1
    s_cmp_ge_u32 s19, 4
    s_cbranch_scc1 L_spd8
    s_cmp_gt_u32 s16, 262144
    s_cbranch_scc1 L_spd8
    s_branch L_sp8
L_spd8:
    v_lshlrev_b32 v4, 3, v6
    v_lshlrev_b32 v5, 4, v6
    ds_read_b64 v[136:137], v4 offset:0
    ds_read_b64 v[138:139], v4 offset:768
    ds_read_b64 v[140:141], v4 offset:1536
    ds_read_b64 v[142:143], v4 offset:2304
    ds_read_b64 v[144:145], v4 offset:512
    ds_read_b64 v[146:147], v4 offset:1280
    ds_read_b64 v[148:149], v4 offset:2048
    ds_read_b64 v[150:151], v4 offset:2816
    v_mov_b32 v130, v14
    v_mov_b32 v131, v15
    v_mov_b32 v134, v14
    v_mov_b32 v135, v15
    s_waitcnt lgkmcnt(4)
    v_add_f32 v136, v136, v138
    v_add_f32 v140, v140, v142
    v_add_f32 v137, v137, v139
    v_add_f32 v141, v141, v143
    v_add_f32 v128, v136, v140
    v_add_f32 v129, v137, v141
    s_cmp_eq_u32 s35, 0
    s_cbranch_scc1 L_gs2
    buffer_store_dwordx4 v[128:131], v5, s[80:83], s12 offen offset:1536 sc1
    s_branch L_gsd2
L_gs2:
    buffer_store_dwordx4 v[128:131], v5, s[80:83], s12 offen offset:1536
L_gsd2:
    s_waitcnt lgkmcnt(0)
    v_add_f32 v144, v144, v146
    v_add_f32 v148, v148, v150
    v_add_f32 v145, v145, v147
    v_add_f32 v149, v149, v151
    v_add_f32 v132, v144, v148
    v_add_f32 v133, v145, v149
    s_mov_b32 exec_hi, 0
    s_cmp_eq_u32 s35, 0
    s_cbranch_scc1 L_gs3
    buffer_store_dwordx4 v[132:135], v5, s[80:83], s12 offen offset:2560 sc1
    s_branch L_gsd3
L_gs3:
    buffer_store_dwordx4 v[132:135], v5, s[80:83], s12 offen offset:2560
L_gsd3:
    s_mov_b64 exec, -1
    s_endpgm
L_merge:
    v_and_b32 v5, 31, v6
    v_lshlrev_b32 v4, 4, v5
    v_lshrrev_b32 v9, 5, v6
    v_lshlrev_b32 v10, 12, v9
    v_add_u32 v4, v4, v10
    v_mov_b32 v3, 1073741824
    v_cmp_gt_u32 s[30:31], 24, v5
    s_nop 1
    v_cndmask_b32 v4, v3, v4, s[30:31]
    v_lshlrev_b32 v10, 4, v9
    v_lshlrev_b32 v5, 1, v5
    v_add_u32 v5, v5, v9
    v_lshrrev_b32 v9, 3, v5
    v_lshlrev_b32 v9, 2, v9
    v_and_b32 v5, 7, v5
    v_lshlrev_b32 v5, 5, v5
    v_add_u32 v5, v5, v9
    s_mul_i32 s6, s32, 384
    s_add_u32 s6, s6, s13
    s_add_u32 s20, s6, 0
    s_add_u32 s21, s6, 8192
    s_add_u32 s22, s6, 16384
    s_add_u32 s23, s6, 24576
    s_mov_b32 s16, 0
    buffer_load_dwordx4 v[96:99], v4, s[80:83], s20 offen offset:1536 sc1
    buffer_load_dwordx4 v[100:103], v4, s[80:83], s21 offen offset:1536 sc1
    buffer_load_dwordx4 v[104:107], v4, s[80:83], s22 offen offset:1536 sc1
    buffer_load_dwordx4 v[108:111], v4, s[80:83], s23 offen offset:1536 sc1
L_po:
    s_waitcnt vmcnt(0)
    v_xor_b32 v3, v98, v14
    v_xor_b32 v9, v99, v15
    v_or_b32 v3, v3, v9
    v_xor_b32 v102, v102, v14
    v_xor_b32 v103, v103, v15
    v_or3_b32 v3, v3, v102, v103
    v_xor_b32 v106, v106, v14
    v_xor_b32 v107, v107, v15
    v_or3_b32 v3, v3, v106, v107
    v_xor_b32 v110, v110, v14
    v_xor_b32 v111, v111, v15
    v_or3_b32 v3, v3, v110, v111
    v_cmp_ne_u32 vcc, 0, v3
    s_and_b64 vcc, vcc, s[30:31]
    s_cbranch_vccz L_po_u0
    buffer_load_dwordx4 v[96:99], v4, s[80:83], s20 offen offset:1536 sc1
    buffer_load_dwordx4 v[100:103], v4, s[80:83], s21 offen offset:1536 sc1
    buffer_load_dwordx4 v[104:107], v4, s[80:83], s22 offen offset:1536 sc1
    buffer_load_dwordx4 v[108:111], v4, s[80:83], s23 offen offset:1536 sc1
    s_add_u32 s16, s16, 1
    s_cmp_le_u32 s16, 16384
    s_cbranch_scc1 L_po
    s_waitcnt vmcnt(0)
L_po_u0:
    v_mov_b32 v2, 0
    s_mov_b32 s16, 0
L_sp9:
    ds_read_b32 v3, v2 offset:7216
    s_waitcnt lgkmcnt(0)
    v_readfirstlane_b32 s19, v3
    s_add_u32 s16, s16, 1
    s_cmp_ge_u32 s19, 1
    s_cbranch_scc1 L_spd9
    s_cmp_gt_u32 s16, 262144
    s_cbranch_scc1 L_spd9
    s_branch L_sp9
L_spd9:
    ds_read_b128 v[56:59], v10 offset:7264
    s_waitcnt lgkmcnt(0)
    v_mul_f32 v11, v56, v96
    v_mul_f32 v12, v56, v97
    v_fmac_f32 v11, v57, v100
    v_fmac_f32 v12, v57, v101
    v_fmac_f32 v11, v58, v104
    v_fmac_f32 v12, v58, v105
    v_fmac_f32 v11, v59, v108
    v_fmac_f32 v12, v59, v109
L_po_fin:
    s_nop 1
    v_permlane32_swap_b32 v11, v12
    s_nop 1
    v_add_f32 v11, v11, v12
    v_cvt_pk_bf16_f32 v11, v11, 0
    s_mov_b64 exec, s[30:31]
    ds_write_b32 v5, v11 offset:7424
    s_waitcnt lgkmcnt(0)
    s_barrier
    s_endpgm
L_stagec:
    v_mov_b32 v16, 0
    v_mov_b32 v17, 0
    v_mov_b32 v18, 0
    v_mov_b32 v19, 0
    v_mov_b32 v20, 0
    v_mov_b32 v21, 0
    v_mov_b32 v22, 0
    v_mov_b32 v23, 0
    v_mov_b32 v2, 0
    s_mov_b32 s16, 0
L_sp10:
    ds_read_b32 v3, v2 offset:7212
    s_waitcnt lgkmcnt(0)
    v_readfirstlane_b32 s19, v3
    s_add_u32 s16, s16, 1
    s_cmp_ge_u32 s19, 1
    s_cbranch_scc1 L_spd10
    s_cmp_gt_u32 s16, 262144
    s_cbranch_scc1 L_spd10
    s_sleep 1
    s_branch L_sp10
L_spd10:
    v_lshrrev_b32 v9, 3, v6
    v_lshlrev_b32 v9, 5, v9
    ds_read_b64 v[38:39], v9 offset:7448
    v_bfe_u32 v4, v6, 1, 2
    v_lshlrev_b32 v4, 14, v4
    v_and_b32 v5, 1, v6
    v_lshlrev_b32 v5, 6, v5
    v_add_u32 v4, v4, v5
    v_and_b32 v5, 48, v6
    v_add_u32 v4, v4, v5
    s_lshl_b32 s6, s5, 16
    s_add_u32 s6, s6, s34
    s_add_u32 s7, s6, 65536
    v_and_b32 v5, 8, v6
    v_cmp_eq_u32 s[30:31], 0, v5
    v_mov_b32 v50, v14
    v_mov_b32 v51, v15
    s_waitcnt vmcnt(6) lgkmcnt(0)
    v_lshlrev_b32 v46, 16, v38
    v_lshlrev_b32 v47, 16, v39
    v_dot2c_f32_bf16 v16, v88, v38
    v_dot2c_f32_bf16 v17, v88, v46
    v_dot2c_f32_bf16 v18, v89, v38
    v_dot2c_f32_bf16 v19, v89, v46
    v_dot2c_f32_bf16 v20, v90, v38
    v_dot2c_f32_bf16 v21, v90, v46
    v_dot2c_f32_bf16 v22, v91, v38
    v_dot2c_f32_bf16 v23, v91, v46
    v_dot2c_f32_bf16 v16, v92, v39
    v_dot2c_f32_bf16 v17, v92, v47
    v_dot2c_f32_bf16 v18, v93, v39
    v_dot2c_f32_bf16 v19, v93, v47
    v_dot2c_f32_bf16 v20, v94, v39
    v_dot2c_f32_bf16 v21, v94, v47
    v_dot2c_f32_bf16 v22, v95, v39
    v_dot2c_f32_bf16 v23, v95, v47
    s_waitcnt vmcnt(0)
    s_barrier
    ds_read_b128 v[32:35], v9 offset:7424
    ds_read_b64 v[36:37], v9 offset:7440
    s_waitcnt lgkmcnt(0)
    v_lshlrev_b32 v40, 16, v32
    v_lshlrev_b32 v41, 16, v33
    v_lshlrev_b32 v42, 16, v34
    v_lshlrev_b32 v43, 16, v35
    v_lshlrev_b32 v44, 16, v36
    v_lshlrev_b32 v45, 16, v37
    v_dot2c_f32_bf16 v16, v64, v32
    v_dot2c_f32_bf16 v17, v64, v40
    v_dot2c_f32_bf16 v18, v65, v32
    v_dot2c_f32_bf16 v19, v65, v40
    v_dot2c_f32_bf16 v20, v66, v32
    v_dot2c_f32_bf16 v21, v66, v40
    v_dot2c_f32_bf16 v22, v67, v32
    v_dot2c_f32_bf16 v23, v67, v40
    v_dot2c_f32_bf16 v16, v68, v33
    v_dot2c_f32_bf16 v17, v68, v41
    v_dot2c_f32_bf16 v18, v69, v33
    v_dot2c_f32_bf16 v19, v69, v41
    v_dot2c_f32_bf16 v20, v70, v33
    v_dot2c_f32_bf16 v21, v70, v41
    v_dot2c_f32_bf16 v22, v71, v33
    v_dot2c_f32_bf16 v23, v71, v41
    v_dot2c_f32_bf16 v16, v72, v34
    v_dot2c_f32_bf16 v17, v72, v42
    v_dot2c_f32_bf16 v18, v73, v34
    v_dot2c_f32_bf16 v19, v73, v42
    v_dot2c_f32_bf16 v20, v74, v34
    v_dot2c_f32_bf16 v21, v74, v42
    v_dot2c_f32_bf16 v22, v75, v34
    v_dot2c_f32_bf16 v23, v75, v42
    v_dot2c_f32_bf16 v16, v76, v35
    v_dot2c_f32_bf16 v17, v76, v43
    v_dot2c_f32_bf16 v18, v77, v35
    v_dot2c_f32_bf16 v19, v77, v43
    v_dot2c_f32_bf16 v20, v78, v35
    v_dot2c_f32_bf16 v21, v78, v43
    v_dot2c_f32_bf16 v22, v79, v35
    v_dot2c_f32_bf16 v23, v79, v43
    v_dot2c_f32_bf16 v16, v80, v36
    v_dot2c_f32_bf16 v17, v80, v44
    v_dot2c_f32_bf16 v18, v81, v36
    v_dot2c_f32_bf16 v19, v81, v44
    v_dot2c_f32_bf16 v20, v82, v36
    v_dot2c_f32_bf16 v21, v82, v44
    v_dot2c_f32_bf16 v22, v83, v36
    v_dot2c_f32_bf16 v23, v83, v44
    v_dot2c_f32_bf16 v16, v84, v37
    v_dot2c_f32_bf16 v17, v84, v45
    v_dot2c_f32_bf16 v18, v85, v37
    v_dot2c_f32_bf16 v19, v85, v45
    v_dot2c_f32_bf16 v20, v86, v37
    v_dot2c_f32_bf16 v21, v86, v45
    v_dot2c_f32_bf16 v22, v87, v37
    v_dot2c_f32_bf16 v23, v87, v45
    s_nop 2
    v_permlane32_swap_b32 v16, v20
    v_permlane32_swap_b32 v17, v21
    v_permlane32_swap_b32 v18, v22
    v_permlane32_swap_b32 v19, v23
    s_nop 1
    v_add_f32 v16, v16, v20
    v_add_f32 v17, v17, v21
    v_add_f32 v18, v18, v22
    v_add_f32 v19, v19, v23
    s_nop 1
    v_permlane16_swap_b32 v16, v18
    v_permlane16_swap_b32 v17, v19
    s_nop 1
    v_add_f32 v16, v16, v18
    v_add_f32 v17, v17, v19
    s_nop 1
    v_add_f32 v16, v16, v16 row_ror:8 row_mask:0xf bank_mask:0xf
    v_add_f32 v17, v17, v17 row_ror:8 row_mask:0xf bank_mask:0xf
    v_mov_b32 v48, v16
    v_mov_b32 v49, v17
    s_mov_b64 exec, s[30:31]
    buffer_store_dwordx4 v[48:51], v4, s[80:83], s6 offen sc1
    s_endpgm
L_final:
    s_cmp_ge_u32 s2, 80
    s_cbranch_scc1 L_end2
    v_lshrrev_b32 v2, 2, v6
    v_lshlrev_b32 v2, 7, v2
    v_and_b32 v4, 3, v6
    v_lshlrev_b32 v5, 4, v4
    v_add_u32 v2, v2, v5
    s_lshr_b32 s6, s2, 1
    s_lshl_b32 s6, s6, 14
    s_and_b32 s7, s2, 1
    s_lshl_b32 s7, s7, 6
    s_add_u32 s6, s6, s7
    s_add_u32 s6, s6, 1048576
    s_add_u32 s21, s6, 4096
    s_add_u32 s22, s6, 8192
    s_add_u32 s23, s6, 12288
    s_mov_b32 s20, s6
    v_lshlrev_b32 v4, 2, v4
    v_lshrrev_b32 v5, 5, v6
    v_lshlrev_b32 v5, 1, v5
    v_add_u32 v4, v4, v5
    s_lshl_b32 s7, s2, 4
    buffer_load_ushort v10, v4, s[40:43], s7 offen
    v_and_b32 v5, 28, v6
    v_cmp_eq_u32 s[30:31], 0, v5
    s_barrier
    s_mov_b32 s16, 0
    buffer_load_dwordx4 v[96:99], v2, s[80:83], s20 offen offset:0 sc1
    buffer_load_dwordx4 v[100:103], v2, s[80:83], s20 offen offset:2048 sc1
    buffer_load_dwordx4 v[104:107], v2, s[80:83], s21 offen offset:0 sc1
    buffer_load_dwordx4 v[108:111], v2, s[80:83], s21 offen offset:2048 sc1
    buffer_load_dwordx4 v[112:115], v2, s[80:83], s22 offen offset:0 sc1
    buffer_load_dwordx4 v[116:119], v2, s[80:83], s22 offen offset:2048 sc1
    buffer_load_dwordx4 v[120:123], v2, s[80:83], s23 offen offset:0 sc1
    buffer_load_dwordx4 v[124:127], v2, s[80:83], s23 offen offset:2048 sc1
L_py:
    s_waitcnt vmcnt(0)
    v_xor_b32 v3, v98, v14
    v_xor_b32 v9, v99, v15
    v_or_b32 v3, v3, v9
    v_xor_b32 v102, v102, v14
    v_xor_b32 v103, v103, v15
    v_or3_b32 v3, v3, v102, v103
    v_xor_b32 v106, v106, v14
    v_xor_b32 v107, v107, v15
    v_or3_b32 v3, v3, v106, v107
    v_xor_b32 v110, v110, v14
    v_xor_b32 v111, v111, v15
    v_or3_b32 v3, v3, v110, v111
    v_xor_b32 v114, v114, v14
    v_xor_b32 v115, v115, v15
    v_or3_b32 v3, v3, v114, v115
    v_xor_b32 v118, v118, v14
    v_xor_b32 v119, v119, v15
    v_or3_b32 v3, v3, v118, v119
    v_xor_b32 v122, v122, v14
    v_xor_b32 v123, v123, v15
    v_or3_b32 v3, v3, v122, v123
    v_xor_b32 v126, v126, v14
    v_xor_b32 v127, v127, v15
    v_or3_b32 v3, v3, v126, v127
    v_cmp_ne_u32 vcc, 0, v3
    s_nop 0
    s_cbranch_vccz L_py_u0
    buffer_load_dwordx4 v[96:99], v2, s[80:83], s20 offen offset:0 sc1
    buffer_load_dwordx4 v[100:103], v2, s[80:83], s20 offen offset:2048 sc1
    buffer_load_dwordx4 v[104:107], v2, s[80:83], s21 offen offset:0 sc1
    buffer_load_dwordx4 v[108:111], v2, s[80:83], s21 offen offset:2048 sc1
    buffer_load_dwordx4 v[112:115], v2, s[80:83], s22 offen offset:0 sc1
    buffer_load_dwordx4 v[116:119], v2, s[80:83], s22 offen offset:2048 sc1
    buffer_load_dwordx4 v[120:123], v2, s[80:83], s23 offen offset:0 sc1
    buffer_load_dwordx4 v[124:127], v2, s[80:83], s23 offen offset:2048 sc1
    s_add_u32 s16, s16, 1
    s_cmp_le_u32 s16, 16384
    s_cbranch_scc1 L_py
    s_waitcnt vmcnt(0)
L_py_u0:
    v_add_f32 v96, v96, v112
    v_add_f32 v97, v97, v113
    v_add_f32 v100, v100, v116
    v_add_f32 v101, v101, v117
    v_add_f32 v104, v104, v120
    v_add_f32 v105, v105, v121
    v_add_f32 v108, v108, v124
    v_add_f32 v109, v109, v125
    v_add_f32 v96, v96, v104
    v_add_f32 v97, v97, v105
    v_add_f32 v100, v100, v108
    v_add_f32 v101, v101, v109
    v_add_f32 v16, v96, v100
    v_add_f32 v17, v97, v101
L_py_fin:
    s_nop 1
    v_permlane32_swap_b32 v16, v17
    s_nop 1
    v_add_f32 v16, v16, v17
    s_nop 1
    v_add_f32 v16, v16, v16 row_ror:8 row_mask:0xf bank_mask:0xf
    s_nop 1
    v_add_f32 v16, v16, v16 row_ror:4 row_mask:0xf bank_mask:0xf
    s_nop 1
    v_mov_b32 v17, v16
    s_nop 1
    v_permlane16_swap_b32 v17, v16
    s_nop 1
    v_add_f32 v16, v16, v17
    v_lshlrev_b32 v10, 16, v10
    v_add_f32 v16, v10, v16
    v_cvt_pk_bf16_f32 v16, v16, v16
    s_mov_b64 exec, s[30:31]
    buffer_store_short v16, v4, s[72:75], s7 offen
L_end2:
L_end:
    s_endpgm
.section .rodata,"a"
.p2align 6
.amdhsa_kernel parallel_sum__sliding_block_cached__glu_gated_swiglu__decode_kernel
  .amdhsa_next_free_vgpr 256
  .amdhsa_next_free_sgpr 102
  .amdhsa_accum_offset 256
  .amdhsa_group_segment_fixed_size 0
  .amdhsa_kernarg_size 96
  .amdhsa_user_sgpr_count 2
  .amdhsa_user_sgpr_kernarg_segment_ptr 1
  .amdhsa_system_sgpr_workgroup_id_x 1
.end_amdhsa_kernel
```
